```python
import torch

def _softmax(x, axis=-1):
    return torch.softmax(x, dim=axis)
def _gelu(x):
    return torch.nn.functional.gelu(x, approximate="tanh")
def _silu(x):
    return torch.nn.functional.silu(x)
def _sigmoid(x):
    return torch.sigmoid(x)
def _layernorm(x, axis=-1, eps=1e-5):
    m = x.mean(dim=axis, keepdim=True)
    v = x.var(dim=axis, keepdim=True, unbiased=False)
    return (x - m) / torch.sqrt(v + eps)
def _scatter_add(tgt, idx, src, axis=0):
    return tgt.clone().index_add_(axis, idx, src)
def _segment_sum(src, seg, n):
    out = torch.zeros((n,) + src.shape[1:], dtype=src.dtype)
    return out.index_add_(0, seg, src)
def _pad(x, pw):
    flat = tuple(v for pair in reversed(pw) for v in pair)
    return torch.nn.functional.pad(x, flat)

kernel_name = 'concat_heads__mha_block_cached__mha_block_cached__near_ridge'

def setup_inputs():

    _w = (lambda a: (lambda t: t.to(torch.bfloat16) if t.is_floating_point() else t)(torch.as_tensor(a)))
    def _A_setup():
        B, Sq, D = 8, 128, 576
        H, Sk, Dh = 32, 1024, 128
        return {
            "x": _w((lambda *s: torch.randn(*s, dtype=torch.bfloat16) * 0.8)(B, Sq, D)),
            "k_cache": _w((lambda *s: torch.randn(*s, dtype=torch.bfloat16) * 0.8)(B, H, Sk, Dh)),
            "v_cache": _w((lambda *s: torch.randn(*s, dtype=torch.bfloat16) * 0.05)(B, H, Sk, Dh)),
            "wq": _w((lambda *s: torch.randn(*s, dtype=torch.bfloat16) * 0.8)(D, H * Dh) * (D ** -0.5)),
            "wo": _w((lambda *s: torch.randn(*s, dtype=torch.bfloat16) * 0.05)(H * Dh, D) * ((H * Dh) ** -0.5)),
        }
    _A_in = _A_setup()

    def _B_setup():
        B, Sq, D = 8, 128, 576
        H, Sk, Dh = 32, 1024, 128
        return {
            "x": _w((lambda *s: torch.randn(*s, dtype=torch.bfloat16) * 0.8)(B, Sq, D)),
            "k_cache": _w((lambda *s: torch.randn(*s, dtype=torch.bfloat16) * 0.8)(B, H, Sk, Dh)),
            "v_cache": _w((lambda *s: torch.randn(*s, dtype=torch.bfloat16) * 0.05)(B, H, Sk, Dh)),
            "wq": _w((lambda *s: torch.randn(*s, dtype=torch.bfloat16) * 0.8)(D, H * Dh) * (D ** -0.5)),
            "wo": _w((lambda *s: torch.randn(*s, dtype=torch.bfloat16) * 0.05)(H * Dh, D) * ((H * Dh) ** -0.5)),
        }
    _B_in = _B_setup()

    return {
        "A_x": _A_in["x"],
        "A_k_cache": _A_in["k_cache"],
        "A_v_cache": _A_in["v_cache"],
        "A_wq": _A_in["wq"],
        "A_wo": _A_in["wo"],
        "B_x": _B_in["x"],
        "B_k_cache": _B_in["k_cache"],
        "B_v_cache": _B_in["v_cache"],
        "B_wq": _B_in["wq"],
        "B_wo": _B_in["wo"],
    }

def reference(A_x, A_k_cache, A_v_cache, A_wq, A_wo, B_x, B_k_cache, B_v_cache, B_wq, B_wo):
    def _A_ref(x, k_cache, v_cache, wq, wo):
        B, Sq, D = x.shape
        H, Dh = 32, 128
        q = (lambda x, *d: x.permute(*d))((x @ wq).reshape(B, Sq, H, Dh), 0, 2, 1, 3)
        scores = torch.einsum("bhqd,bhkd->bhqk", q, k_cache) * (Dh ** -0.5)
        p = _softmax(scores, axis=-1)
        o = torch.einsum("bhqk,bhkd->bhqd", p, v_cache)
        return (lambda x, *d: x.permute(*d))(o, 0, 2, 1, 3).reshape(B, Sq, H * Dh) @ wo

    def _B_ref(x, k_cache, v_cache, wq, wo):
        B, Sq, D = x.shape
        H, Dh = 32, 128
        q = (lambda x, *d: x.permute(*d))((x @ wq).reshape(B, Sq, H, Dh), 0, 2, 1, 3)
        scores = torch.einsum("bhqd,bhkd->bhqk", q, k_cache) * (Dh ** -0.5)
        p = _softmax(scores, axis=-1)
        o = torch.einsum("bhqk,bhkd->bhqd", p, v_cache)
        return (lambda x, *d: x.permute(*d))(o, 0, 2, 1, 3).reshape(B, Sq, H * Dh) @ wo

    a = _A_ref(A_x, A_k_cache, A_v_cache, A_wq, A_wo)
    b = _B_ref(B_x, B_k_cache, B_v_cache, B_wq, B_wo)
    return torch.concatenate([a, b], axis=-1)
```

```asm
; @launch kernel=attn_kernel grid=(512,1,1) block=(256,1,1) lds=81920
; @launch kernel=oproj_kernel grid=(256,1,1) block=(256,1,1) lds=163840
.amdgcn_target "amdgcn-amd-amdhsa--gfx950"
.text
.globl attn_kernel
.p2align 8
.type attn_kernel,@function
attn_kernel:
    s_cmp_ge_u32 s2, 512
    s_cbranch_scc1 L_attn_end
    s_bfe_u32 s40, s2, 0x10002
    s_and_b32 s3, s2, 3
    s_bfe_u32 s4, s2, 0x30003
    s_lshl_b32 s3, s3, 3
    s_or_b32 s38, s3, s4
    s_lshr_b32 s39, s2, 6
    s_mul_i32 s3, s40, 40
    s_add_u32 s4, s0, s3
    s_addc_u32 s5, s1, 0
    s_load_dwordx8 s[28:35], s[4:5], 0
    s_load_dwordx2 s[36:37], s[0:1], 96
    s_load_dwordx2 s[96:97], s[0:1], 88
    v_and_b32 v14, 63, v0
    v_lshrrev_b32 v10, 6, v0
    s_nop 0
    v_readfirstlane_b32 s50, v10
    s_lshl_b32 s43, s50, 12
    v_lshlrev_b32 v247, 12, v10
    v_lshl_add_u32 v247, v14, 4, v247
    v_lshrrev_b32 v11, 4, v14
    v_and_b32 v12, 15, v14
    v_lshl_add_u32 v13, v10, 4, v11
    v_lshlrev_b32 v9, 2, v11
    v_xor_b32 v9, v9, v12
    v_lshlrev_b32 v9, 4, v9
    v_add_u32 v200, 0, v13
    v_lshl_add_u32 v200, v200, 13, v9
    v_add_u32 v201, 4, v13
    v_lshl_add_u32 v201, v201, 13, v9
    v_subrev_u32 v201, 1024, v201
    v_add_u32 v202, 8, v13
    v_lshl_add_u32 v202, v202, 13, v9
    v_subrev_u32 v202, 2048, v202
    v_add_u32 v203, 12, v13
    v_lshl_add_u32 v203, v203, 13, v9
    v_subrev_u32 v203, 3072, v203
    v_lshl_add_u32 v9, v13, 8, v9
    v_add_u32 v5, 0, v11
    v_xor_b32 v5, v5, v12
    v_lshlrev_b32 v5, 4, v5
    v_lshl_add_u32 v5, v13, 8, v5
    v_add_u32 v6, 4, v11
    v_xor_b32 v6, v6, v12
    v_lshlrev_b32 v6, 4, v6
    v_lshl_add_u32 v6, v13, 8, v6
    v_add_u32 v7, 8, v11
    v_xor_b32 v7, v7, v12
    v_lshlrev_b32 v7, 4, v7
    v_lshl_add_u32 v7, v13, 8, v7
    v_add_u32 v8, 12, v11
    v_xor_b32 v8, v8, v12
    v_lshlrev_b32 v8, 4, v8
    v_lshl_add_u32 v8, v13, 8, v8
    v_lshrrev_b32 v11, 3, v14
    v_lshl_add_u32 v11, v10, 5, v11
    v_mul_u32_u24 v11, 1152, v11
    v_lshrrev_b32 v12, 4, v14
    v_and_b32 v13, 7, v14
    v_add_u32 v204, 0, v12
    v_and_b32 v204, 7, v204
    v_xor_b32 v204, v204, v13
    v_lshl_add_u32 v204, v204, 4, v11
    v_add_u32 v204, 0, v204
    v_add_u32 v205, 4, v12
    v_and_b32 v205, 7, v205
    v_xor_b32 v205, v205, v13
    v_lshl_add_u32 v205, v205, 4, v11
    v_add_u32 v205, 8192, v205
    v_add_u32 v206, 8, v12
    v_and_b32 v206, 7, v206
    v_xor_b32 v206, v206, v13
    v_lshl_add_u32 v206, v206, 4, v11
    v_add_u32 v206, 16384, v206
    v_add_u32 v207, 12, v12
    v_and_b32 v207, 7, v207
    v_xor_b32 v207, v207, v13
    v_lshl_add_u32 v207, v207, 4, v11
    v_add_u32 v207, 24576, v207
    v_and_b32 v11, 31, v14
    v_bfe_u32 v12, v14, 1, 3
    v_lshrrev_b32 v13, 5, v14
    v_xor_b32 v12, v12, v13
    v_lshl_add_u32 v11, v10, 5, v11
    v_lshlrev_b32 v11, 7, v11
    v_xor_b32 v13, 0, v12
    v_lshl_add_u32 v208, v13, 4, v11
    v_xor_b32 v13, 2, v12
    v_lshl_add_u32 v209, v13, 4, v11
    v_xor_b32 v13, 4, v12
    v_lshl_add_u32 v210, v13, 4, v11
    v_xor_b32 v13, 6, v12
    v_lshl_add_u32 v211, v13, 4, v11
    v_add_u32 v208, 49152, v208
    v_add_u32 v209, 49152, v209
    v_add_u32 v210, 49152, v210
    v_add_u32 v211, 49152, v211
    v_lshrrev_b32 v10, 5, v14
    v_bfe_u32 v11, v14, 2, 2
    v_lshl_add_u32 v10, v10, 3, v11
    v_lshlrev_b32 v10, 8, v10
    v_bfe_u32 v12, v14, 4, 1
    v_lshl_add_u32 v10, v12, 5, v10
    v_and_b32 v12, 1, v14
    v_bfe_u32 v13, v14, 1, 1
    v_lshl_add_u32 v10, v12, 4, v10
    v_lshl_add_u32 v10, v13, 3, v10
    v_add_u32 v10, 0, v10
    v_xor_b32 v12, 0, v11
    v_lshl_add_u32 v1, v12, 6, v10
    v_xor_b32 v12, 1, v11
    v_lshl_add_u32 v2, v12, 6, v10
    v_xor_b32 v12, 2, v11
    v_lshl_add_u32 v3, v12, 6, v10
    v_xor_b32 v12, 3, v11
    v_lshl_add_u32 v4, v12, 6, v10
    s_waitcnt lgkmcnt(0)
    s_lshl_b32 s3, s39, 5
    s_add_u32 s3, s3, s38
    s_lshl_b32 s3, s3, 18
    s_add_u32 s8, s30, s3
    s_addc_u32 s9, s31, 0
    s_mov_b32 s10, 262144
    s_mov_b32 s11, 0x20000
    s_add_u32 s12, s32, s3
    s_addc_u32 s13, s33, 0
    s_mov_b32 s14, 262144
    s_mov_b32 s15, 0x20000
    s_mul_i32 s3, s39, 147456
    s_add_u32 s20, s28, s3
    s_addc_u32 s21, s29, 0
    s_mov_b32 s22, 147456
    s_mov_b32 s23, 0x20000
    s_lshl_b32 s3, s38, 8
    s_add_u32 s16, s34, s3
    s_addc_u32 s17, s35, 0
    s_sub_u32 s18, 4718592, s3
    s_mov_b32 s19, 0x20000
    s_lshl_b32 s3, s40, 3
    s_add_u32 s3, s3, s39
    s_lshl_b32 s3, s3, 20
    s_lshl_b32 s4, s38, 12
    s_add_u32 s3, s3, s4
    s_add_u32 s24, s36, s3
    s_addc_u32 s25, s37, 0
    s_sub_u32 s26, 1048576, s4
    s_mov_b32 s27, 0x20000
    s_mov_b32 s48, 0x3e0293ee
    s_mov_b32 s98, 256
    s_mov_b32 s99, 0x20000
    s_mov_b32 s42, 0
    s_mov_b32 s44, 0
    s_mov_b32 s45, 0
    s_and_b32 s3, s38, 7
    s_add_u32 s3, s3, s39
    s_cmp_ge_u32 s3, 9
    s_cselect_b32 s4, 9, 0
    s_sub_u32 s3, s3, s4
    s_lshl_b32 s46, s3, 19
    s_lshl_b32 s53, s3, 7
    s_mov_b32 s42, 49152
    s_add_u32 m0, s42, s43
    s_add_u32 s42, s42, 16384
    buffer_load_dwordx4 v204, s[20:23], s53 offen offset:0 lds
    buffer_load_dwordx4 v205, s[20:23], s53 offen offset:1024 lds
    buffer_load_dwordx4 v206, s[20:23], s53 offen offset:2048 lds
    buffer_load_dwordx4 v207, s[20:23], s53 offen offset:3072 lds
    s_add_u32 s53, s53, 128
    s_cmp_eq_u32 s42, 81920
    s_cselect_b32 s42, 0, s42
    s_cmp_eq_u32 s53, 1152
    s_cselect_b32 s53, 0, s53
    s_mov_b32 s42, 0
    s_add_u32 m0, s42, s43
    s_add_u32 s42, s42, 16384
    buffer_load_dwordx4 v200, s[16:19], s46 offen offset:0 lds
    buffer_load_dwordx4 v201, s[16:19], s46 offen offset:1024 lds
    buffer_load_dwordx4 v202, s[16:19], s46 offen offset:2048 lds
    buffer_load_dwordx4 v203, s[16:19], s46 offen offset:3072 lds
    s_add_u32 s46, s46, 524288
    s_cmp_eq_u32 s42, 81920
    s_cselect_b32 s42, 0, s42
    s_cmp_eq_u32 s46, 4718592
    s_cselect_b32 s46, 0, s46
    s_mov_b32 s42, 65536
    s_add_u32 m0, s42, s43
    s_add_u32 s42, s42, 16384
    buffer_load_dwordx4 v204, s[20:23], s53 offen offset:0 lds
    buffer_load_dwordx4 v205, s[20:23], s53 offen offset:1024 lds
    buffer_load_dwordx4 v206, s[20:23], s53 offen offset:2048 lds
    buffer_load_dwordx4 v207, s[20:23], s53 offen offset:3072 lds
    s_add_u32 s53, s53, 128
    s_cmp_eq_u32 s42, 81920
    s_cselect_b32 s42, 0, s42
    s_cmp_eq_u32 s53, 1152
    s_cselect_b32 s53, 0, s53
    s_mov_b32 s42, 16384
    s_add_u32 m0, s42, s43
    s_add_u32 s42, s42, 16384
    buffer_load_dwordx4 v200, s[16:19], s46 offen offset:0 lds
    buffer_load_dwordx4 v201, s[16:19], s46 offen offset:1024 lds
    buffer_load_dwordx4 v202, s[16:19], s46 offen offset:2048 lds
    buffer_load_dwordx4 v203, s[16:19], s46 offen offset:3072 lds
    s_add_u32 s46, s46, 524288
    s_cmp_eq_u32 s42, 81920
    s_cselect_b32 s42, 0, s42
    s_cmp_eq_u32 s46, 4718592
    s_cselect_b32 s46, 0, s46
    s_mov_b32 s42, 32768
    s_add_u32 m0, s42, s43
    s_add_u32 s42, s42, 16384
    buffer_load_dwordx4 v200, s[16:19], s46 offen offset:0 lds
    buffer_load_dwordx4 v201, s[16:19], s46 offen offset:1024 lds
    buffer_load_dwordx4 v202, s[16:19], s46 offen offset:2048 lds
    buffer_load_dwordx4 v203, s[16:19], s46 offen offset:3072 lds
    s_add_u32 s46, s46, 524288
    s_cmp_eq_u32 s42, 81920
    s_cselect_b32 s42, 0, s42
    s_cmp_eq_u32 s46, 4718592
    s_cselect_b32 s46, 0, s46
    s_waitcnt vmcnt(16)
    s_waitcnt vmcnt(12)
    s_barrier
    ds_read_b128 v[184:187], v208
    ds_read_b64_tr_b16 v[88:89], v1 offset:0
    ds_read_b64_tr_b16 v[90:91], v1 offset:1024
    ds_read_b64_tr_b16 v[92:93], v2 offset:0
    ds_read_b64_tr_b16 v[94:95], v2 offset:1024
    ds_read_b128 v[188:191], v209
    ds_read_b128 v[192:195], v210
    ds_read_b128 v[196:199], v211
    ds_read_b64_tr_b16 v[96:97], v3 offset:0
    ds_read_b64_tr_b16 v[98:99], v3 offset:1024
    ds_read_b64_tr_b16 v[100:101], v4 offset:0
    ds_read_b64_tr_b16 v[102:103], v4 offset:1024
    ds_read_b64_tr_b16 v[104:105], v1 offset:4096
    ds_read_b64_tr_b16 v[106:107], v1 offset:5120
    s_waitcnt lgkmcnt(11)
    v_mfma_f32_32x32x16_bf16 v[24:39], v[88:91], v[184:187], 0
    ds_read_b64_tr_b16 v[108:109], v2 offset:4096
    ds_read_b64_tr_b16 v[110:111], v2 offset:5120
    v_add_u32 v208, 0x4000, v208
    v_add_u32 v209, 0x4000, v209
    v_add_u32 v210, 0x4000, v210
    v_add_u32 v211, 0x4000, v211
    s_waitcnt lgkmcnt(8)
    s_mov_b32 s42, 49152
    s_add_u32 m0, s42, s43
    s_add_u32 s42, s42, 16384
    buffer_load_dwordx4 v204, s[20:23], s53 offen offset:0 lds
    v_mfma_f32_32x32x16_bf16 v[40:55], v[92:95], v[184:187], 0
    ds_read_b64_tr_b16 v[112:113], v3 offset:4096
    ds_read_b64_tr_b16 v[114:115], v3 offset:5120
    ds_read_b64_tr_b16 v[116:117], v4 offset:4096
    ds_read_b64_tr_b16 v[118:119], v4 offset:5120
    buffer_load_dwordx4 v205, s[20:23], s53 offen offset:1024 lds
    s_waitcnt lgkmcnt(10)
    v_mfma_f32_32x32x16_bf16 v[56:71], v[96:99], v[184:187], 0
    ds_read_b64_tr_b16 v[88:89], v1 offset:8192
    ds_read_b64_tr_b16 v[90:91], v1 offset:9216
    buffer_load_dwordx4 v206, s[20:23], s53 offen offset:2048 lds
    s_waitcnt lgkmcnt(10)
    v_mfma_f32_32x32x16_bf16 v[72:87], v[100:103], v[184:187], 0
    ds_read_b64_tr_b16 v[92:93], v2 offset:8192
    ds_read_b64_tr_b16 v[94:95], v2 offset:9216
    buffer_load_dwordx4 v207, s[20:23], s53 offen offset:3072 lds
    s_add_u32 s53, s53, 128
    s_cmp_eq_u32 s42, 81920
    s_cselect_b32 s42, 0, s42
    s_cmp_eq_u32 s53, 1152
    s_cselect_b32 s53, 0, s53
    s_waitcnt lgkmcnt(10)
    v_mfma_f32_32x32x16_bf16 v[24:39], v[104:107], v[188:191], v[24:39]
    ds_read_b64_tr_b16 v[96:97], v3 offset:8192
    ds_read_b64_tr_b16 v[98:99], v3 offset:9216
    s_waitcnt lgkmcnt(10)
    v_mfma_f32_32x32x16_bf16 v[40:55], v[108:111], v[188:191], v[40:55]
    ds_read_b64_tr_b16 v[100:101], v4 offset:8192
    ds_read_b64_tr_b16 v[102:103], v4 offset:9216
    s_waitcnt lgkmcnt(10)
    v_mfma_f32_32x32x16_bf16 v[56:71], v[112:115], v[188:191], v[56:71]
    ds_read_b64_tr_b16 v[104:105], v1 offset:12288
    ds_read_b64_tr_b16 v[106:107], v1 offset:13312
    s_waitcnt lgkmcnt(10)
    v_mfma_f32_32x32x16_bf16 v[72:87], v[116:119], v[188:191], v[72:87]
    ds_read_b64_tr_b16 v[108:109], v2 offset:12288
    ds_read_b64_tr_b16 v[110:111], v2 offset:13312
    s_waitcnt lgkmcnt(10)
    v_mfma_f32_32x32x16_bf16 v[24:39], v[88:91], v[192:195], v[24:39]
    ds_read_b64_tr_b16 v[112:113], v3 offset:12288
    ds_read_b64_tr_b16 v[114:115], v3 offset:13312
    s_waitcnt lgkmcnt(10)
    v_mfma_f32_32x32x16_bf16 v[40:55], v[92:95], v[192:195], v[40:55]
    ds_read_b64_tr_b16 v[116:117], v4 offset:12288
    ds_read_b64_tr_b16 v[118:119], v4 offset:13312
    s_waitcnt lgkmcnt(10)
    v_mfma_f32_32x32x16_bf16 v[56:71], v[96:99], v[192:195], v[56:71]
    s_waitcnt lgkmcnt(8)
    v_mfma_f32_32x32x16_bf16 v[72:87], v[100:103], v[192:195], v[72:87]
    s_waitcnt lgkmcnt(6)
    v_mfma_f32_32x32x16_bf16 v[24:39], v[104:107], v[196:199], v[24:39]
    s_waitcnt lgkmcnt(4)
    v_mfma_f32_32x32x16_bf16 v[40:55], v[108:111], v[196:199], v[40:55]
    s_waitcnt lgkmcnt(2)
    v_mfma_f32_32x32x16_bf16 v[56:71], v[112:115], v[196:199], v[56:71]
    s_waitcnt lgkmcnt(0)
    v_mfma_f32_32x32x16_bf16 v[72:87], v[116:119], v[196:199], v[72:87]
    v_add_u32 v1, 0x4000, v1
    v_add_u32 v2, 0x4000, v2
    v_add_u32 v3, 0x4000, v3
    v_add_u32 v4, 0x4000, v4
    s_waitcnt vmcnt(12)
    s_waitcnt vmcnt(8)
    s_barrier
    ds_read_b128 v[184:187], v208
    ds_read_b64_tr_b16 v[88:89], v1 offset:0
    ds_read_b64_tr_b16 v[90:91], v1 offset:1024
    ds_read_b64_tr_b16 v[92:93], v2 offset:0
    ds_read_b64_tr_b16 v[94:95], v2 offset:1024
    ds_read_b128 v[188:191], v209
    ds_read_b128 v[192:195], v210
    ds_read_b128 v[196:199], v211
    ds_read_b64_tr_b16 v[96:97], v3 offset:0
    ds_read_b64_tr_b16 v[98:99], v3 offset:1024
    ds_read_b64_tr_b16 v[100:101], v4 offset:0
    ds_read_b64_tr_b16 v[102:103], v4 offset:1024
    ds_read_b64_tr_b16 v[104:105], v1 offset:4096
    ds_read_b64_tr_b16 v[106:107], v1 offset:5120
    s_waitcnt lgkmcnt(11)
    v_mfma_f32_32x32x16_bf16 v[24:39], v[88:91], v[184:187], v[24:39]
    ds_read_b64_tr_b16 v[108:109], v2 offset:4096
    ds_read_b64_tr_b16 v[110:111], v2 offset:5120
    v_add_u32 v208, 0xffffc000, v208
    v_add_u32 v209, 0xffffc000, v209
    v_add_u32 v210, 0xffffc000, v210
    v_add_u32 v211, 0xffffc000, v211
    s_mov_b32 s42, 0
    s_add_u32 m0, s42, s43
    s_add_u32 s42, s42, 16384
    buffer_load_dwordx4 v200, s[16:19], s46 offen offset:0 lds
    s_waitcnt lgkmcnt(11)
    v_mfma_f32_32x32x16_bf16 v[40:55], v[92:95], v[184:187], v[40:55]
    ds_read_b64_tr_b16 v[112:113], v3 offset:4096
    ds_read_b64_tr_b16 v[114:115], v3 offset:5120
    buffer_load_dwordx4 v201, s[16:19], s46 offen offset:1024 lds
    s_waitcnt lgkmcnt(8)
    v_mfma_f32_32x32x16_bf16 v[56:71], v[96:99], v[184:187], v[56:71]
    ds_read_b64_tr_b16 v[116:117], v4 offset:4096
    ds_read_b64_tr_b16 v[118:119], v4 offset:5120
    ds_read_b64_tr_b16 v[88:89], v1 offset:8192
    ds_read_b64_tr_b16 v[90:91], v1 offset:9216
    buffer_load_dwordx4 v202, s[16:19], s46 offen offset:2048 lds
    s_waitcnt lgkmcnt(10)
    v_mfma_f32_32x32x16_bf16 v[72:87], v[100:103], v[184:187], v[72:87]
    ds_read_b64_tr_b16 v[92:93], v2 offset:8192
    ds_read_b64_tr_b16 v[94:95], v2 offset:9216
    buffer_load_dwordx4 v203, s[16:19], s46 offen offset:3072 lds
    s_add_u32 s46, s46, 524288
    s_cmp_eq_u32 s42, 81920
    s_cselect_b32 s42, 0, s42
    s_cmp_eq_u32 s46, 4718592
    s_cselect_b32 s46, 0, s46
    s_waitcnt lgkmcnt(10)
    v_mfma_f32_32x32x16_bf16 v[24:39], v[104:107], v[188:191], v[24:39]
    ds_read_b64_tr_b16 v[96:97], v3 offset:8192
    ds_read_b64_tr_b16 v[98:99], v3 offset:9216
    s_mov_b32 s42, 65536
    s_add_u32 m0, s42, s43
    s_add_u32 s42, s42, 16384
    buffer_load_dwordx4 v204, s[20:23], s53 offen offset:0 lds
    s_waitcnt lgkmcnt(10)
    v_mfma_f32_32x32x16_bf16 v[40:55], v[108:111], v[188:191], v[40:55]
    ds_read_b64_tr_b16 v[100:101], v4 offset:8192
    ds_read_b64_tr_b16 v[102:103], v4 offset:9216
    buffer_load_dwordx4 v205, s[20:23], s53 offen offset:1024 lds
    s_waitcnt lgkmcnt(10)
    v_mfma_f32_32x32x16_bf16 v[56:71], v[112:115], v[188:191], v[56:71]
    ds_read_b64_tr_b16 v[104:105], v1 offset:12288
    ds_read_b64_tr_b16 v[106:107], v1 offset:13312
    buffer_load_dwordx4 v206, s[20:23], s53 offen offset:2048 lds
    s_waitcnt lgkmcnt(10)
    v_mfma_f32_32x32x16_bf16 v[72:87], v[116:119], v[188:191], v[72:87]
    ds_read_b64_tr_b16 v[108:109], v2 offset:12288
    ds_read_b64_tr_b16 v[110:111], v2 offset:13312
    buffer_load_dwordx4 v207, s[20:23], s53 offen offset:3072 lds
    s_add_u32 s53, s53, 128
    s_cmp_eq_u32 s42, 81920
    s_cselect_b32 s42, 0, s42
    s_cmp_eq_u32 s53, 1152
    s_cselect_b32 s53, 0, s53
    s_waitcnt lgkmcnt(10)
    v_mfma_f32_32x32x16_bf16 v[24:39], v[88:91], v[192:195], v[24:39]
    ds_read_b64_tr_b16 v[112:113], v3 offset:12288
    ds_read_b64_tr_b16 v[114:115], v3 offset:13312
    s_waitcnt lgkmcnt(10)
    v_mfma_f32_32x32x16_bf16 v[40:55], v[92:95], v[192:195], v[40:55]
    ds_read_b64_tr_b16 v[116:117], v4 offset:12288
    ds_read_b64_tr_b16 v[118:119], v4 offset:13312
    s_waitcnt lgkmcnt(10)
    v_mfma_f32_32x32x16_bf16 v[56:71], v[96:99], v[192:195], v[56:71]
    s_waitcnt lgkmcnt(8)
    v_mfma_f32_32x32x16_bf16 v[72:87], v[100:103], v[192:195], v[72:87]
    s_waitcnt lgkmcnt(6)
    v_mfma_f32_32x32x16_bf16 v[24:39], v[104:107], v[196:199], v[24:39]
    s_waitcnt lgkmcnt(4)
    v_mfma_f32_32x32x16_bf16 v[40:55], v[108:111], v[196:199], v[40:55]
    s_waitcnt lgkmcnt(2)
    v_mfma_f32_32x32x16_bf16 v[56:71], v[112:115], v[196:199], v[56:71]
    s_waitcnt lgkmcnt(0)
    v_mfma_f32_32x32x16_bf16 v[72:87], v[116:119], v[196:199], v[72:87]
    v_add_u32 v1, 0x4000, v1
    v_add_u32 v2, 0x4000, v2
    v_add_u32 v3, 0x4000, v3
    v_add_u32 v4, 0x4000, v4
    s_waitcnt vmcnt(8)
    s_barrier
    ds_read_b128 v[184:187], v208
    ds_read_b64_tr_b16 v[88:89], v1 offset:0
    ds_read_b64_tr_b16 v[90:91], v1 offset:1024
    ds_read_b64_tr_b16 v[92:93], v2 offset:0
    ds_read_b64_tr_b16 v[94:95], v2 offset:1024
    ds_read_b128 v[188:191], v209
    ds_read_b128 v[192:195], v210
    ds_read_b128 v[196:199], v211
    ds_read_b64_tr_b16 v[96:97], v3 offset:0
    ds_read_b64_tr_b16 v[98:99], v3 offset:1024
    ds_read_b64_tr_b16 v[100:101], v4 offset:0
    ds_read_b64_tr_b16 v[102:103], v4 offset:1024
    ds_read_b64_tr_b16 v[104:105], v1 offset:4096
    ds_read_b64_tr_b16 v[106:107], v1 offset:5120
    s_waitcnt lgkmcnt(11)
    v_mfma_f32_32x32x16_bf16 v[24:39], v[88:91], v[184:187], v[24:39]
    ds_read_b64_tr_b16 v[108:109], v2 offset:4096
    ds_read_b64_tr_b16 v[110:111], v2 offset:5120
    v_add_u32 v208, 0x4000, v208
    v_add_u32 v209, 0x4000, v209
    v_add_u32 v210, 0x4000, v210
    v_add_u32 v211, 0x4000, v211
    s_mov_b32 s42, 16384
    s_add_u32 m0, s42, s43
    s_add_u32 s42, s42, 16384
    buffer_load_dwordx4 v200, s[16:19], s46 offen offset:0 lds
    s_waitcnt lgkmcnt(11)
    v_mfma_f32_32x32x16_bf16 v[40:55], v[92:95], v[184:187], v[40:55]
    ds_read_b64_tr_b16 v[112:113], v3 offset:4096
    ds_read_b64_tr_b16 v[114:115], v3 offset:5120
    buffer_load_dwordx4 v201, s[16:19], s46 offen offset:1024 lds
    s_waitcnt lgkmcnt(8)
    v_mfma_f32_32x32x16_bf16 v[56:71], v[96:99], v[184:187], v[56:71]
    ds_read_b64_tr_b16 v[116:117], v4 offset:4096
    ds_read_b64_tr_b16 v[118:119], v4 offset:5120
    ds_read_b64_tr_b16 v[88:89], v1 offset:8192
    ds_read_b64_tr_b16 v[90:91], v1 offset:9216
    buffer_load_dwordx4 v202, s[16:19], s46 offen offset:2048 lds
    s_waitcnt lgkmcnt(10)
    v_mfma_f32_32x32x16_bf16 v[72:87], v[100:103], v[184:187], v[72:87]
    ds_read_b64_tr_b16 v[92:93], v2 offset:8192
    ds_read_b64_tr_b16 v[94:95], v2 offset:9216
    buffer_load_dwordx4 v203, s[16:19], s46 offen offset:3072 lds
    s_add_u32 s46, s46, 524288
    s_cmp_eq_u32 s42, 81920
    s_cselect_b32 s42, 0, s42
    s_cmp_eq_u32 s46, 4718592
    s_cselect_b32 s46, 0, s46
    s_waitcnt lgkmcnt(10)
    v_mfma_f32_32x32x16_bf16 v[24:39], v[104:107], v[188:191], v[24:39]
    ds_read_b64_tr_b16 v[96:97], v3 offset:8192
    ds_read_b64_tr_b16 v[98:99], v3 offset:9216
    s_mov_b32 s42, 49152
    s_add_u32 m0, s42, s43
    s_add_u32 s42, s42, 16384
    buffer_load_dwordx4 v204, s[20:23], s53 offen offset:0 lds
    s_waitcnt lgkmcnt(10)
    v_mfma_f32_32x32x16_bf16 v[40:55], v[108:111], v[188:191], v[40:55]
    ds_read_b64_tr_b16 v[100:101], v4 offset:8192
    ds_read_b64_tr_b16 v[102:103], v4 offset:9216
    buffer_load_dwordx4 v205, s[20:23], s53 offen offset:1024 lds
    s_waitcnt lgkmcnt(10)
    v_mfma_f32_32x32x16_bf16 v[56:71], v[112:115], v[188:191], v[56:71]
    ds_read_b64_tr_b16 v[104:105], v1 offset:12288
    ds_read_b64_tr_b16 v[106:107], v1 offset:13312
    buffer_load_dwordx4 v206, s[20:23], s53 offen offset:2048 lds
    s_waitcnt lgkmcnt(10)
    v_mfma_f32_32x32x16_bf16 v[72:87], v[116:119], v[188:191], v[72:87]
    ds_read_b64_tr_b16 v[108:109], v2 offset:12288
    ds_read_b64_tr_b16 v[110:111], v2 offset:13312
    buffer_load_dwordx4 v207, s[20:23], s53 offen offset:3072 lds
    s_add_u32 s53, s53, 128
    s_cmp_eq_u32 s42, 81920
    s_cselect_b32 s42, 0, s42
    s_cmp_eq_u32 s53, 1152
    s_cselect_b32 s53, 0, s53
    s_waitcnt lgkmcnt(10)
    v_mfma_f32_32x32x16_bf16 v[24:39], v[88:91], v[192:195], v[24:39]
    ds_read_b64_tr_b16 v[112:113], v3 offset:12288
    ds_read_b64_tr_b16 v[114:115], v3 offset:13312
    s_waitcnt lgkmcnt(10)
    v_mfma_f32_32x32x16_bf16 v[40:55], v[92:95], v[192:195], v[40:55]
    ds_read_b64_tr_b16 v[116:117], v4 offset:12288
    ds_read_b64_tr_b16 v[118:119], v4 offset:13312
    s_waitcnt lgkmcnt(10)
    v_mfma_f32_32x32x16_bf16 v[56:71], v[96:99], v[192:195], v[56:71]
    s_waitcnt lgkmcnt(8)
    v_mfma_f32_32x32x16_bf16 v[72:87], v[100:103], v[192:195], v[72:87]
    s_waitcnt lgkmcnt(6)
    v_mfma_f32_32x32x16_bf16 v[24:39], v[104:107], v[196:199], v[24:39]
    s_waitcnt lgkmcnt(4)
    v_mfma_f32_32x32x16_bf16 v[40:55], v[108:111], v[196:199], v[40:55]
    s_waitcnt lgkmcnt(2)
    v_mfma_f32_32x32x16_bf16 v[56:71], v[112:115], v[196:199], v[56:71]
    s_waitcnt lgkmcnt(0)
    v_mfma_f32_32x32x16_bf16 v[72:87], v[116:119], v[196:199], v[72:87]
    v_add_u32 v1, 0xffff8000, v1
    v_add_u32 v2, 0xffff8000, v2
    v_add_u32 v3, 0xffff8000, v3
    v_add_u32 v4, 0xffff8000, v4
    s_waitcnt vmcnt(8)
    s_barrier
    ds_read_b128 v[184:187], v208
    ds_read_b64_tr_b16 v[88:89], v1 offset:0
    ds_read_b64_tr_b16 v[90:91], v1 offset:1024
    ds_read_b64_tr_b16 v[92:93], v2 offset:0
    ds_read_b64_tr_b16 v[94:95], v2 offset:1024
    ds_read_b128 v[188:191], v209
    ds_read_b128 v[192:195], v210
    ds_read_b128 v[196:199], v211
    ds_read_b64_tr_b16 v[96:97], v3 offset:0
    ds_read_b64_tr_b16 v[98:99], v3 offset:1024
    ds_read_b64_tr_b16 v[100:101], v4 offset:0
    ds_read_b64_tr_b16 v[102:103], v4 offset:1024
    ds_read_b64_tr_b16 v[104:105], v1 offset:4096
    ds_read_b64_tr_b16 v[106:107], v1 offset:5120
    s_waitcnt lgkmcnt(11)
    v_mfma_f32_32x32x16_bf16 v[24:39], v[88:91], v[184:187], v[24:39]
    ds_read_b64_tr_b16 v[108:109], v2 offset:4096
    ds_read_b64_tr_b16 v[110:111], v2 offset:5120
    v_add_u32 v208, 0xffffc000, v208
    v_add_u32 v209, 0xffffc000, v209
    v_add_u32 v210, 0xffffc000, v210
    v_add_u32 v211, 0xffffc000, v211
    s_mov_b32 s42, 32768
    s_add_u32 m0, s42, s43
    s_add_u32 s42, s42, 16384
    buffer_load_dwordx4 v200, s[16:19], s46 offen offset:0 lds
    s_waitcnt lgkmcnt(11)
    v_mfma_f32_32x32x16_bf16 v[40:55], v[92:95], v[184:187], v[40:55]
    ds_read_b64_tr_b16 v[112:113], v3 offset:4096
    ds_read_b64_tr_b16 v[114:115], v3 offset:5120
    buffer_load_dwordx4 v201, s[16:19], s46 offen offset:1024 lds
    s_waitcnt lgkmcnt(8)
    v_mfma_f32_32x32x16_bf16 v[56:71], v[96:99], v[184:187], v[56:71]
    ds_read_b64_tr_b16 v[116:117], v4 offset:4096
    ds_read_b64_tr_b16 v[118:119], v4 offset:5120
    ds_read_b64_tr_b16 v[88:89], v1 offset:8192
    ds_read_b64_tr_b16 v[90:91], v1 offset:9216
    buffer_load_dwordx4 v202, s[16:19], s46 offen offset:2048 lds
    s_waitcnt lgkmcnt(10)
    v_mfma_f32_32x32x16_bf16 v[72:87], v[100:103], v[184:187], v[72:87]
    ds_read_b64_tr_b16 v[92:93], v2 offset:8192
    ds_read_b64_tr_b16 v[94:95], v2 offset:9216
    buffer_load_dwordx4 v203, s[16:19], s46 offen offset:3072 lds
    s_add_u32 s46, s46, 524288
    s_cmp_eq_u32 s42, 81920
    s_cselect_b32 s42, 0, s42
    s_cmp_eq_u32 s46, 4718592
    s_cselect_b32 s46, 0, s46
    s_waitcnt lgkmcnt(10)
    v_mfma_f32_32x32x16_bf16 v[24:39], v[104:107], v[188:191], v[24:39]
    ds_read_b64_tr_b16 v[96:97], v3 offset:8192
    ds_read_b64_tr_b16 v[98:99], v3 offset:9216
    s_mov_b32 s42, 65536
    s_add_u32 m0, s42, s43
    s_add_u32 s42, s42, 16384
    buffer_load_dwordx4 v204, s[20:23], s53 offen offset:0 lds
    s_waitcnt lgkmcnt(10)
    v_mfma_f32_32x32x16_bf16 v[40:55], v[108:111], v[188:191], v[40:55]
    ds_read_b64_tr_b16 v[100:101], v4 offset:8192
    ds_read_b64_tr_b16 v[102:103], v4 offset:9216
    buffer_load_dwordx4 v205, s[20:23], s53 offen offset:1024 lds
    s_waitcnt lgkmcnt(10)
    v_mfma_f32_32x32x16_bf16 v[56:71], v[112:115], v[188:191], v[56:71]
    ds_read_b64_tr_b16 v[104:105], v1 offset:12288
    ds_read_b64_tr_b16 v[106:107], v1 offset:13312
    buffer_load_dwordx4 v206, s[20:23], s53 offen offset:2048 lds
    s_waitcnt lgkmcnt(10)
    v_mfma_f32_32x32x16_bf16 v[72:87], v[116:119], v[188:191], v[72:87]
    ds_read_b64_tr_b16 v[108:109], v2 offset:12288
    ds_read_b64_tr_b16 v[110:111], v2 offset:13312
    buffer_load_dwordx4 v207, s[20:23], s53 offen offset:3072 lds
    s_add_u32 s53, s53, 128
    s_cmp_eq_u32 s42, 81920
    s_cselect_b32 s42, 0, s42
    s_cmp_eq_u32 s53, 1152
    s_cselect_b32 s53, 0, s53
    s_waitcnt lgkmcnt(10)
    v_mfma_f32_32x32x16_bf16 v[24:39], v[88:91], v[192:195], v[24:39]
    ds_read_b64_tr_b16 v[112:113], v3 offset:12288
    ds_read_b64_tr_b16 v[114:115], v3 offset:13312
    s_waitcnt lgkmcnt(10)
    v_mfma_f32_32x32x16_bf16 v[40:55], v[92:95], v[192:195], v[40:55]
    ds_read_b64_tr_b16 v[116:117], v4 offset:12288
    ds_read_b64_tr_b16 v[118:119], v4 offset:13312
    s_waitcnt lgkmcnt(10)
    v_mfma_f32_32x32x16_bf16 v[56:71], v[96:99], v[192:195], v[56:71]
    s_waitcnt lgkmcnt(8)
    v_mfma_f32_32x32x16_bf16 v[72:87], v[100:103], v[192:195], v[72:87]
    s_waitcnt lgkmcnt(6)
    v_mfma_f32_32x32x16_bf16 v[24:39], v[104:107], v[196:199], v[24:39]
    s_waitcnt lgkmcnt(4)
    v_mfma_f32_32x32x16_bf16 v[40:55], v[108:111], v[196:199], v[40:55]
    s_waitcnt lgkmcnt(2)
    v_mfma_f32_32x32x16_bf16 v[56:71], v[112:115], v[196:199], v[56:71]
    s_waitcnt lgkmcnt(0)
    v_mfma_f32_32x32x16_bf16 v[72:87], v[116:119], v[196:199], v[72:87]
    v_add_u32 v1, 0x4000, v1
    v_add_u32 v2, 0x4000, v2
    v_add_u32 v3, 0x4000, v3
    v_add_u32 v4, 0x4000, v4
    s_waitcnt vmcnt(8)
    s_barrier
    ds_read_b128 v[184:187], v208
    ds_read_b64_tr_b16 v[88:89], v1 offset:0
    ds_read_b64_tr_b16 v[90:91], v1 offset:1024
    ds_read_b64_tr_b16 v[92:93], v2 offset:0
    ds_read_b64_tr_b16 v[94:95], v2 offset:1024
    ds_read_b128 v[188:191], v209
    ds_read_b128 v[192:195], v210
    ds_read_b128 v[196:199], v211
    ds_read_b64_tr_b16 v[96:97], v3 offset:0
    ds_read_b64_tr_b16 v[98:99], v3 offset:1024
    ds_read_b64_tr_b16 v[100:101], v4 offset:0
    ds_read_b64_tr_b16 v[102:103], v4 offset:1024
    ds_read_b64_tr_b16 v[104:105], v1 offset:4096
    ds_read_b64_tr_b16 v[106:107], v1 offset:5120
    s_waitcnt lgkmcnt(11)
    v_mfma_f32_32x32x16_bf16 v[24:39], v[88:91], v[184:187], v[24:39]
    ds_read_b64_tr_b16 v[108:109], v2 offset:4096
    ds_read_b64_tr_b16 v[110:111], v2 offset:5120
    v_add_u32 v208, 0x4000, v208
    v_add_u32 v209, 0x4000, v209
    v_add_u32 v210, 0x4000, v210
    v_add_u32 v211, 0x4000, v211
    s_mov_b32 s42, 0
    s_add_u32 m0, s42, s43
    s_add_u32 s42, s42, 16384
    buffer_load_dwordx4 v200, s[16:19], s46 offen offset:0 lds
    s_waitcnt lgkmcnt(11)
    v_mfma_f32_32x32x16_bf16 v[40:55], v[92:95], v[184:187], v[40:55]
    ds_read_b64_tr_b16 v[112:113], v3 offset:4096
    ds_read_b64_tr_b16 v[114:115], v3 offset:5120
    buffer_load_dwordx4 v201, s[16:19], s46 offen offset:1024 lds
    s_waitcnt lgkmcnt(8)
    v_mfma_f32_32x32x16_bf16 v[56:71], v[96:99], v[184:187], v[56:71]
    ds_read_b64_tr_b16 v[116:117], v4 offset:4096
    ds_read_b64_tr_b16 v[118:119], v4 offset:5120
    ds_read_b64_tr_b16 v[88:89], v1 offset:8192
    ds_read_b64_tr_b16 v[90:91], v1 offset:9216
    buffer_load_dwordx4 v202, s[16:19], s46 offen offset:2048 lds
    s_waitcnt lgkmcnt(10)
    v_mfma_f32_32x32x16_bf16 v[72:87], v[100:103], v[184:187], v[72:87]
    ds_read_b64_tr_b16 v[92:93], v2 offset:8192
    ds_read_b64_tr_b16 v[94:95], v2 offset:9216
    buffer_load_dwordx4 v203, s[16:19], s46 offen offset:3072 lds
    s_add_u32 s46, s46, 524288
    s_cmp_eq_u32 s42, 81920
    s_cselect_b32 s42, 0, s42
    s_cmp_eq_u32 s46, 4718592
    s_cselect_b32 s46, 0, s46
    s_waitcnt lgkmcnt(10)
    v_mfma_f32_32x32x16_bf16 v[24:39], v[104:107], v[188:191], v[24:39]
    ds_read_b64_tr_b16 v[96:97], v3 offset:8192
    ds_read_b64_tr_b16 v[98:99], v3 offset:9216
    s_mov_b32 s42, 49152
    s_add_u32 m0, s42, s43
    s_add_u32 s42, s42, 16384
    buffer_load_dwordx4 v204, s[20:23], s53 offen offset:0 lds
    s_waitcnt lgkmcnt(10)
    v_mfma_f32_32x32x16_bf16 v[40:55], v[108:111], v[188:191], v[40:55]
    ds_read_b64_tr_b16 v[100:101], v4 offset:8192
    ds_read_b64_tr_b16 v[102:103], v4 offset:9216
    buffer_load_dwordx4 v205, s[20:23], s53 offen offset:1024 lds
    s_waitcnt lgkmcnt(10)
    v_mfma_f32_32x32x16_bf16 v[56:71], v[112:115], v[188:191], v[56:71]
    ds_read_b64_tr_b16 v[104:105], v1 offset:12288
    ds_read_b64_tr_b16 v[106:107], v1 offset:13312
    buffer_load_dwordx4 v206, s[20:23], s53 offen offset:2048 lds
    s_waitcnt lgkmcnt(10)
    v_mfma_f32_32x32x16_bf16 v[72:87], v[116:119], v[188:191], v[72:87]
    ds_read_b64_tr_b16 v[108:109], v2 offset:12288
    ds_read_b64_tr_b16 v[110:111], v2 offset:13312
    buffer_load_dwordx4 v207, s[20:23], s53 offen offset:3072 lds
    s_add_u32 s53, s53, 128
    s_cmp_eq_u32 s42, 81920
    s_cselect_b32 s42, 0, s42
    s_cmp_eq_u32 s53, 1152
    s_cselect_b32 s53, 0, s53
    s_waitcnt lgkmcnt(10)
    v_mfma_f32_32x32x16_bf16 v[24:39], v[88:91], v[192:195], v[24:39]
    ds_read_b64_tr_b16 v[112:113], v3 offset:12288
    ds_read_b64_tr_b16 v[114:115], v3 offset:13312
    s_waitcnt lgkmcnt(10)
    v_mfma_f32_32x32x16_bf16 v[40:55], v[92:95], v[192:195], v[40:55]
    ds_read_b64_tr_b16 v[116:117], v4 offset:12288
    ds_read_b64_tr_b16 v[118:119], v4 offset:13312
    s_waitcnt lgkmcnt(10)
    v_mfma_f32_32x32x16_bf16 v[56:71], v[96:99], v[192:195], v[56:71]
    s_waitcnt lgkmcnt(8)
    v_mfma_f32_32x32x16_bf16 v[72:87], v[100:103], v[192:195], v[72:87]
    s_waitcnt lgkmcnt(6)
    v_mfma_f32_32x32x16_bf16 v[24:39], v[104:107], v[196:199], v[24:39]
    s_waitcnt lgkmcnt(4)
    v_mfma_f32_32x32x16_bf16 v[40:55], v[108:111], v[196:199], v[40:55]
    s_waitcnt lgkmcnt(2)
    v_mfma_f32_32x32x16_bf16 v[56:71], v[112:115], v[196:199], v[56:71]
    s_waitcnt lgkmcnt(0)
    v_mfma_f32_32x32x16_bf16 v[72:87], v[116:119], v[196:199], v[72:87]
    v_add_u32 v1, 0x4000, v1
    v_add_u32 v2, 0x4000, v2
    v_add_u32 v3, 0x4000, v3
    v_add_u32 v4, 0x4000, v4
    s_waitcnt vmcnt(8)
    s_barrier
    ds_read_b128 v[184:187], v208
    ds_read_b64_tr_b16 v[88:89], v1 offset:0
    ds_read_b64_tr_b16 v[90:91], v1 offset:1024
    ds_read_b64_tr_b16 v[92:93], v2 offset:0
    ds_read_b64_tr_b16 v[94:95], v2 offset:1024
    ds_read_b128 v[188:191], v209
    ds_read_b128 v[192:195], v210
    ds_read_b128 v[196:199], v211
    ds_read_b64_tr_b16 v[96:97], v3 offset:0
    ds_read_b64_tr_b16 v[98:99], v3 offset:1024
    ds_read_b64_tr_b16 v[100:101], v4 offset:0
    ds_read_b64_tr_b16 v[102:103], v4 offset:1024
    ds_read_b64_tr_b16 v[104:105], v1 offset:4096
    ds_read_b64_tr_b16 v[106:107], v1 offset:5120
    s_waitcnt lgkmcnt(11)
    v_mfma_f32_32x32x16_bf16 v[24:39], v[88:91], v[184:187], v[24:39]
    ds_read_b64_tr_b16 v[108:109], v2 offset:4096
    ds_read_b64_tr_b16 v[110:111], v2 offset:5120
    v_add_u32 v208, 0xffffc000, v208
    v_add_u32 v209, 0xffffc000, v209
    v_add_u32 v210, 0xffffc000, v210
    v_add_u32 v211, 0xffffc000, v211
    s_mov_b32 s42, 16384
    s_add_u32 m0, s42, s43
    s_add_u32 s42, s42, 16384
    buffer_load_dwordx4 v200, s[16:19], s46 offen offset:0 lds
    s_waitcnt lgkmcnt(11)
    v_mfma_f32_32x32x16_bf16 v[40:55], v[92:95], v[184:187], v[40:55]
    ds_read_b64_tr_b16 v[112:113], v3 offset:4096
    ds_read_b64_tr_b16 v[114:115], v3 offset:5120
    buffer_load_dwordx4 v201, s[16:19], s46 offen offset:1024 lds
    s_waitcnt lgkmcnt(8)
    v_mfma_f32_32x32x16_bf16 v[56:71], v[96:99], v[184:187], v[56:71]
    ds_read_b64_tr_b16 v[116:117], v4 offset:4096
    ds_read_b64_tr_b16 v[118:119], v4 offset:5120
    ds_read_b64_tr_b16 v[88:89], v1 offset:8192
    ds_read_b64_tr_b16 v[90:91], v1 offset:9216
    buffer_load_dwordx4 v202, s[16:19], s46 offen offset:2048 lds
    s_waitcnt lgkmcnt(10)
    v_mfma_f32_32x32x16_bf16 v[72:87], v[100:103], v[184:187], v[72:87]
    ds_read_b64_tr_b16 v[92:93], v2 offset:8192
    ds_read_b64_tr_b16 v[94:95], v2 offset:9216
    buffer_load_dwordx4 v203, s[16:19], s46 offen offset:3072 lds
    s_add_u32 s46, s46, 524288
    s_cmp_eq_u32 s42, 81920
    s_cselect_b32 s42, 0, s42
    s_cmp_eq_u32 s46, 4718592
    s_cselect_b32 s46, 0, s46
    s_waitcnt lgkmcnt(10)
    v_mfma_f32_32x32x16_bf16 v[24:39], v[104:107], v[188:191], v[24:39]
    ds_read_b64_tr_b16 v[96:97], v3 offset:8192
    ds_read_b64_tr_b16 v[98:99], v3 offset:9216
    s_mov_b32 s42, 65536
    s_add_u32 m0, s42, s43
    s_add_u32 s42, s42, 16384
    buffer_load_dwordx4 v204, s[20:23], s53 offen offset:0 lds
    s_waitcnt lgkmcnt(10)
    v_mfma_f32_32x32x16_bf16 v[40:55], v[108:111], v[188:191], v[40:55]
    ds_read_b64_tr_b16 v[100:101], v4 offset:8192
    ds_read_b64_tr_b16 v[102:103], v4 offset:9216
    buffer_load_dwordx4 v205, s[20:23], s53 offen offset:1024 lds
    s_waitcnt lgkmcnt(10)
    v_mfma_f32_32x32x16_bf16 v[56:71], v[112:115], v[188:191], v[56:71]
    ds_read_b64_tr_b16 v[104:105], v1 offset:12288
    ds_read_b64_tr_b16 v[106:107], v1 offset:13312
    buffer_load_dwordx4 v206, s[20:23], s53 offen offset:2048 lds
    s_waitcnt lgkmcnt(10)
    v_mfma_f32_32x32x16_bf16 v[72:87], v[116:119], v[188:191], v[72:87]
    ds_read_b64_tr_b16 v[108:109], v2 offset:12288
    ds_read_b64_tr_b16 v[110:111], v2 offset:13312
    buffer_load_dwordx4 v207, s[20:23], s53 offen offset:3072 lds
    s_add_u32 s53, s53, 128
    s_cmp_eq_u32 s42, 81920
    s_cselect_b32 s42, 0, s42
    s_cmp_eq_u32 s53, 1152
    s_cselect_b32 s53, 0, s53
    s_waitcnt lgkmcnt(10)
    v_mfma_f32_32x32x16_bf16 v[24:39], v[88:91], v[192:195], v[24:39]
    ds_read_b64_tr_b16 v[112:113], v3 offset:12288
    ds_read_b64_tr_b16 v[114:115], v3 offset:13312
    s_waitcnt lgkmcnt(10)
    v_mfma_f32_32x32x16_bf16 v[40:55], v[92:95], v[192:195], v[40:55]
    ds_read_b64_tr_b16 v[116:117], v4 offset:12288
    ds_read_b64_tr_b16 v[118:119], v4 offset:13312
    s_waitcnt lgkmcnt(10)
    v_mfma_f32_32x32x16_bf16 v[56:71], v[96:99], v[192:195], v[56:71]
    s_waitcnt lgkmcnt(8)
    v_mfma_f32_32x32x16_bf16 v[72:87], v[100:103], v[192:195], v[72:87]
    s_waitcnt lgkmcnt(6)
    v_mfma_f32_32x32x16_bf16 v[24:39], v[104:107], v[196:199], v[24:39]
    s_waitcnt lgkmcnt(4)
    v_mfma_f32_32x32x16_bf16 v[40:55], v[108:111], v[196:199], v[40:55]
    s_waitcnt lgkmcnt(2)
    v_mfma_f32_32x32x16_bf16 v[56:71], v[112:115], v[196:199], v[56:71]
    s_waitcnt lgkmcnt(0)
    v_mfma_f32_32x32x16_bf16 v[72:87], v[116:119], v[196:199], v[72:87]
    v_add_u32 v1, 0xffff8000, v1
    v_add_u32 v2, 0xffff8000, v2
    v_add_u32 v3, 0xffff8000, v3
    v_add_u32 v4, 0xffff8000, v4
    s_waitcnt vmcnt(8)
    s_barrier
    ds_read_b128 v[184:187], v208
    ds_read_b64_tr_b16 v[88:89], v1 offset:0
    ds_read_b64_tr_b16 v[90:91], v1 offset:1024
    ds_read_b64_tr_b16 v[92:93], v2 offset:0
    ds_read_b64_tr_b16 v[94:95], v2 offset:1024
    ds_read_b128 v[188:191], v209
    ds_read_b128 v[192:195], v210
    ds_read_b128 v[196:199], v211
    ds_read_b64_tr_b16 v[96:97], v3 offset:0
    ds_read_b64_tr_b16 v[98:99], v3 offset:1024
    ds_read_b64_tr_b16 v[100:101], v4 offset:0
    ds_read_b64_tr_b16 v[102:103], v4 offset:1024
    ds_read_b64_tr_b16 v[104:105], v1 offset:4096
    ds_read_b64_tr_b16 v[106:107], v1 offset:5120
    s_waitcnt lgkmcnt(11)
    v_mfma_f32_32x32x16_bf16 v[24:39], v[88:91], v[184:187], v[24:39]
    ds_read_b64_tr_b16 v[108:109], v2 offset:4096
    ds_read_b64_tr_b16 v[110:111], v2 offset:5120
    v_add_u32 v208, 0x4000, v208
    v_add_u32 v209, 0x4000, v209
    v_add_u32 v210, 0x4000, v210
    v_add_u32 v211, 0x4000, v211
    s_mov_b32 s42, 32768
    s_add_u32 m0, s42, s43
    s_add_u32 s42, s42, 16384
    buffer_load_dwordx4 v200, s[16:19], s46 offen offset:0 lds
    s_waitcnt lgkmcnt(11)
    v_mfma_f32_32x32x16_bf16 v[40:55], v[92:95], v[184:187], v[40:55]
    ds_read_b64_tr_b16 v[112:113], v3 offset:4096
    ds_read_b64_tr_b16 v[114:115], v3 offset:5120
    buffer_load_dwordx4 v201, s[16:19], s46 offen offset:1024 lds
    s_waitcnt lgkmcnt(8)
    v_mfma_f32_32x32x16_bf16 v[56:71], v[96:99], v[184:187], v[56:71]
    ds_read_b64_tr_b16 v[116:117], v4 offset:4096
    ds_read_b64_tr_b16 v[118:119], v4 offset:5120
    ds_read_b64_tr_b16 v[88:89], v1 offset:8192
    ds_read_b64_tr_b16 v[90:91], v1 offset:9216
    buffer_load_dwordx4 v202, s[16:19], s46 offen offset:2048 lds
    s_waitcnt lgkmcnt(10)
    v_mfma_f32_32x32x16_bf16 v[72:87], v[100:103], v[184:187], v[72:87]
    ds_read_b64_tr_b16 v[92:93], v2 offset:8192
    ds_read_b64_tr_b16 v[94:95], v2 offset:9216
    buffer_load_dwordx4 v203, s[16:19], s46 offen offset:3072 lds
    s_add_u32 s46, s46, 524288
    s_cmp_eq_u32 s42, 81920
    s_cselect_b32 s42, 0, s42
    s_cmp_eq_u32 s46, 4718592
    s_cselect_b32 s46, 0, s46
    s_waitcnt lgkmcnt(10)
    v_mfma_f32_32x32x16_bf16 v[24:39], v[104:107], v[188:191], v[24:39]
    ds_read_b64_tr_b16 v[96:97], v3 offset:8192
    ds_read_b64_tr_b16 v[98:99], v3 offset:9216
    s_mov_b32 s42, 49152
    s_add_u32 m0, s42, s43
    s_add_u32 s42, s42, 16384
    buffer_load_dwordx4 v204, s[20:23], s53 offen offset:0 lds
    s_waitcnt lgkmcnt(10)
    v_mfma_f32_32x32x16_bf16 v[40:55], v[108:111], v[188:191], v[40:55]
    ds_read_b64_tr_b16 v[100:101], v4 offset:8192
    ds_read_b64_tr_b16 v[102:103], v4 offset:9216
    buffer_load_dwordx4 v205, s[20:23], s53 offen offset:1024 lds
    s_waitcnt lgkmcnt(10)
    v_mfma_f32_32x32x16_bf16 v[56:71], v[112:115], v[188:191], v[56:71]
    ds_read_b64_tr_b16 v[104:105], v1 offset:12288
    ds_read_b64_tr_b16 v[106:107], v1 offset:13312
    buffer_load_dwordx4 v206, s[20:23], s53 offen offset:2048 lds
    s_waitcnt lgkmcnt(10)
    v_mfma_f32_32x32x16_bf16 v[72:87], v[116:119], v[188:191], v[72:87]
    ds_read_b64_tr_b16 v[108:109], v2 offset:12288
    ds_read_b64_tr_b16 v[110:111], v2 offset:13312
    buffer_load_dwordx4 v207, s[20:23], s53 offen offset:3072 lds
    s_add_u32 s53, s53, 128
    s_cmp_eq_u32 s42, 81920
    s_cselect_b32 s42, 0, s42
    s_cmp_eq_u32 s53, 1152
    s_cselect_b32 s53, 0, s53
    s_waitcnt lgkmcnt(10)
    v_mfma_f32_32x32x16_bf16 v[24:39], v[88:91], v[192:195], v[24:39]
    ds_read_b64_tr_b16 v[112:113], v3 offset:12288
    ds_read_b64_tr_b16 v[114:115], v3 offset:13312
    s_waitcnt lgkmcnt(10)
    v_mfma_f32_32x32x16_bf16 v[40:55], v[92:95], v[192:195], v[40:55]
    ds_read_b64_tr_b16 v[116:117], v4 offset:12288
    ds_read_b64_tr_b16 v[118:119], v4 offset:13312
    s_waitcnt lgkmcnt(10)
    v_mfma_f32_32x32x16_bf16 v[56:71], v[96:99], v[192:195], v[56:71]
    s_waitcnt lgkmcnt(8)
    v_mfma_f32_32x32x16_bf16 v[72:87], v[100:103], v[192:195], v[72:87]
    s_waitcnt lgkmcnt(6)
    v_mfma_f32_32x32x16_bf16 v[24:39], v[104:107], v[196:199], v[24:39]
    s_waitcnt lgkmcnt(4)
    v_mfma_f32_32x32x16_bf16 v[40:55], v[108:111], v[196:199], v[40:55]
    s_waitcnt lgkmcnt(2)
    v_mfma_f32_32x32x16_bf16 v[56:71], v[112:115], v[196:199], v[56:71]
    s_waitcnt lgkmcnt(0)
    v_mfma_f32_32x32x16_bf16 v[72:87], v[116:119], v[196:199], v[72:87]
    v_add_u32 v1, 0x4000, v1
    v_add_u32 v2, 0x4000, v2
    v_add_u32 v3, 0x4000, v3
    v_add_u32 v4, 0x4000, v4
    s_waitcnt vmcnt(8)
    s_barrier
    ds_read_b128 v[184:187], v208
    ds_read_b64_tr_b16 v[88:89], v1 offset:0
    ds_read_b64_tr_b16 v[90:91], v1 offset:1024
    ds_read_b64_tr_b16 v[92:93], v2 offset:0
    ds_read_b64_tr_b16 v[94:95], v2 offset:1024
    ds_read_b128 v[188:191], v209
    ds_read_b128 v[192:195], v210
    ds_read_b128 v[196:199], v211
    ds_read_b64_tr_b16 v[96:97], v3 offset:0
    ds_read_b64_tr_b16 v[98:99], v3 offset:1024
    ds_read_b64_tr_b16 v[100:101], v4 offset:0
    ds_read_b64_tr_b16 v[102:103], v4 offset:1024
    ds_read_b64_tr_b16 v[104:105], v1 offset:4096
    ds_read_b64_tr_b16 v[106:107], v1 offset:5120
    s_waitcnt lgkmcnt(11)
    v_mfma_f32_32x32x16_bf16 v[24:39], v[88:91], v[184:187], v[24:39]
    ds_read_b64_tr_b16 v[108:109], v2 offset:4096
    ds_read_b64_tr_b16 v[110:111], v2 offset:5120
    v_add_u32 v208, 0xffffc000, v208
    v_add_u32 v209, 0xffffc000, v209
    v_add_u32 v210, 0xffffc000, v210
    v_add_u32 v211, 0xffffc000, v211
    s_mov_b32 s42, 0
    s_add_u32 m0, s42, s43
    s_add_u32 s42, s42, 16384
    buffer_load_dwordx4 v5, s[8:11], s44 offen offset:0 nt lds
    s_waitcnt lgkmcnt(11)
    v_mfma_f32_32x32x16_bf16 v[40:55], v[92:95], v[184:187], v[40:55]
    ds_read_b64_tr_b16 v[112:113], v3 offset:4096
    ds_read_b64_tr_b16 v[114:115], v3 offset:5120
    buffer_load_dwordx4 v6, s[8:11], s44 offen offset:1024 nt lds
    s_waitcnt lgkmcnt(8)
    v_mfma_f32_32x32x16_bf16 v[56:71], v[96:99], v[184:187], v[56:71]
    ds_read_b64_tr_b16 v[116:117], v4 offset:4096
    ds_read_b64_tr_b16 v[118:119], v4 offset:5120
    ds_read_b64_tr_b16 v[88:89], v1 offset:8192
    ds_read_b64_tr_b16 v[90:91], v1 offset:9216
    buffer_load_dwordx4 v7, s[8:11], s44 offen offset:2048 nt lds
    s_waitcnt lgkmcnt(10)
    v_mfma_f32_32x32x16_bf16 v[72:87], v[100:103], v[184:187], v[72:87]
    ds_read_b64_tr_b16 v[92:93], v2 offset:8192
    ds_read_b64_tr_b16 v[94:95], v2 offset:9216
    buffer_load_dwordx4 v8, s[8:11], s44 offen offset:3072 nt lds
    s_add_u32 s44, s44, 16384
    s_cmp_eq_u32 s42, 81920
    s_cselect_b32 s42, 0, s42
    s_waitcnt lgkmcnt(10)
    v_mfma_f32_32x32x16_bf16 v[24:39], v[104:107], v[188:191], v[24:39]
    ds_read_b64_tr_b16 v[96:97], v3 offset:8192
    ds_read_b64_tr_b16 v[98:99], v3 offset:9216
    s_waitcnt lgkmcnt(10)
    v_mfma_f32_32x32x16_bf16 v[40:55], v[108:111], v[188:191], v[40:55]
    ds_read_b64_tr_b16 v[100:101], v4 offset:8192
    ds_read_b64_tr_b16 v[102:103], v4 offset:9216
    s_waitcnt lgkmcnt(10)
    v_mfma_f32_32x32x16_bf16 v[56:71], v[112:115], v[188:191], v[56:71]
    ds_read_b64_tr_b16 v[104:105], v1 offset:12288
    ds_read_b64_tr_b16 v[106:107], v1 offset:13312
    s_waitcnt lgkmcnt(10)
    v_mfma_f32_32x32x16_bf16 v[72:87], v[116:119], v[188:191], v[72:87]
    ds_read_b64_tr_b16 v[108:109], v2 offset:12288
    ds_read_b64_tr_b16 v[110:111], v2 offset:13312
    s_waitcnt lgkmcnt(10)
    v_mfma_f32_32x32x16_bf16 v[24:39], v[88:91], v[192:195], v[24:39]
    ds_read_b64_tr_b16 v[112:113], v3 offset:12288
    ds_read_b64_tr_b16 v[114:115], v3 offset:13312
    s_waitcnt lgkmcnt(10)
    v_mfma_f32_32x32x16_bf16 v[40:55], v[92:95], v[192:195], v[40:55]
    ds_read_b64_tr_b16 v[116:117], v4 offset:12288
    ds_read_b64_tr_b16 v[118:119], v4 offset:13312
    s_waitcnt lgkmcnt(10)
    v_mfma_f32_32x32x16_bf16 v[56:71], v[96:99], v[192:195], v[56:71]
    s_waitcnt lgkmcnt(8)
    v_mfma_f32_32x32x16_bf16 v[72:87], v[100:103], v[192:195], v[72:87]
    s_waitcnt lgkmcnt(6)
    v_mfma_f32_32x32x16_bf16 v[24:39], v[104:107], v[196:199], v[24:39]
    s_waitcnt lgkmcnt(4)
    v_mfma_f32_32x32x16_bf16 v[40:55], v[108:111], v[196:199], v[40:55]
    s_waitcnt lgkmcnt(2)
    v_mfma_f32_32x32x16_bf16 v[56:71], v[112:115], v[196:199], v[56:71]
    s_waitcnt lgkmcnt(0)
    v_mfma_f32_32x32x16_bf16 v[72:87], v[116:119], v[196:199], v[72:87]
    v_add_u32 v1, 0x4000, v1
    v_add_u32 v2, 0x4000, v2
    v_add_u32 v3, 0x4000, v3
    v_add_u32 v4, 0x4000, v4
    s_waitcnt vmcnt(4)
    s_barrier
    ds_read_b128 v[184:187], v208
    ds_read_b64_tr_b16 v[88:89], v1 offset:0
    ds_read_b64_tr_b16 v[90:91], v1 offset:1024
    ds_read_b64_tr_b16 v[92:93], v2 offset:0
    ds_read_b64_tr_b16 v[94:95], v2 offset:1024
    ds_read_b128 v[188:191], v209
    ds_read_b128 v[192:195], v210
    ds_read_b128 v[196:199], v211
    ds_read_b64_tr_b16 v[96:97], v3 offset:0
    ds_read_b64_tr_b16 v[98:99], v3 offset:1024
    ds_read_b64_tr_b16 v[100:101], v4 offset:0
    ds_read_b64_tr_b16 v[102:103], v4 offset:1024
    ds_read_b64_tr_b16 v[104:105], v1 offset:4096
    ds_read_b64_tr_b16 v[106:107], v1 offset:5120
    s_waitcnt lgkmcnt(11)
    v_mfma_f32_32x32x16_bf16 v[24:39], v[88:91], v[184:187], v[24:39]
    ds_read_b64_tr_b16 v[108:109], v2 offset:4096
    ds_read_b64_tr_b16 v[110:111], v2 offset:5120
    s_mov_b32 s42, 16384
    s_add_u32 m0, s42, s43
    s_add_u32 s42, s42, 16384
    buffer_load_dwordx4 v5, s[8:11], s44 offen offset:0 nt lds
    s_waitcnt lgkmcnt(11)
    v_mfma_f32_32x32x16_bf16 v[40:55], v[92:95], v[184:187], v[40:55]
    ds_read_b64_tr_b16 v[112:113], v3 offset:4096
    ds_read_b64_tr_b16 v[114:115], v3 offset:5120
    buffer_load_dwordx4 v6, s[8:11], s44 offen offset:1024 nt lds
    s_waitcnt lgkmcnt(8)
    v_mfma_f32_32x32x16_bf16 v[56:71], v[96:99], v[184:187], v[56:71]
    ds_read_b64_tr_b16 v[116:117], v4 offset:4096
    ds_read_b64_tr_b16 v[118:119], v4 offset:5120
    ds_read_b64_tr_b16 v[88:89], v1 offset:8192
    ds_read_b64_tr_b16 v[90:91], v1 offset:9216
    buffer_load_dwordx4 v7, s[8:11], s44 offen offset:2048 nt lds
    s_waitcnt lgkmcnt(10)
    v_mfma_f32_32x32x16_bf16 v[72:87], v[100:103], v[184:187], v[72:87]
    ds_read_b64_tr_b16 v[92:93], v2 offset:8192
    ds_read_b64_tr_b16 v[94:95], v2 offset:9216
    buffer_load_dwordx4 v8, s[8:11], s44 offen offset:3072 nt lds
    s_add_u32 s44, s44, 16384
    s_cmp_eq_u32 s42, 81920
    s_cselect_b32 s42, 0, s42
    s_waitcnt lgkmcnt(10)
    v_mfma_f32_32x32x16_bf16 v[24:39], v[104:107], v[188:191], v[24:39]
    ds_read_b64_tr_b16 v[96:97], v3 offset:8192
    ds_read_b64_tr_b16 v[98:99], v3 offset:9216
    s_waitcnt lgkmcnt(10)
    v_mfma_f32_32x32x16_bf16 v[40:55], v[108:111], v[188:191], v[40:55]
    ds_read_b64_tr_b16 v[100:101], v4 offset:8192
    ds_read_b64_tr_b16 v[102:103], v4 offset:9216
    s_waitcnt lgkmcnt(10)
    v_mfma_f32_32x32x16_bf16 v[56:71], v[112:115], v[188:191], v[56:71]
    ds_read_b64_tr_b16 v[104:105], v1 offset:12288
    ds_read_b64_tr_b16 v[106:107], v1 offset:13312
    s_waitcnt lgkmcnt(10)
    v_mfma_f32_32x32x16_bf16 v[72:87], v[116:119], v[188:191], v[72:87]
    ds_read_b64_tr_b16 v[108:109], v2 offset:12288
    ds_read_b64_tr_b16 v[110:111], v2 offset:13312
    s_waitcnt lgkmcnt(10)
    v_mfma_f32_32x32x16_bf16 v[24:39], v[88:91], v[192:195], v[24:39]
    ds_read_b64_tr_b16 v[112:113], v3 offset:12288
    ds_read_b64_tr_b16 v[114:115], v3 offset:13312
    s_waitcnt lgkmcnt(10)
    v_mfma_f32_32x32x16_bf16 v[40:55], v[92:95], v[192:195], v[40:55]
    ds_read_b64_tr_b16 v[116:117], v4 offset:12288
    ds_read_b64_tr_b16 v[118:119], v4 offset:13312
    s_waitcnt lgkmcnt(10)
    v_mfma_f32_32x32x16_bf16 v[56:71], v[96:99], v[192:195], v[56:71]
    s_waitcnt lgkmcnt(8)
    v_mfma_f32_32x32x16_bf16 v[72:87], v[100:103], v[192:195], v[72:87]
    s_waitcnt lgkmcnt(6)
    v_mfma_f32_32x32x16_bf16 v[24:39], v[104:107], v[196:199], v[24:39]
    s_waitcnt lgkmcnt(4)
    v_mfma_f32_32x32x16_bf16 v[40:55], v[108:111], v[196:199], v[40:55]
    s_waitcnt lgkmcnt(2)
    v_mfma_f32_32x32x16_bf16 v[56:71], v[112:115], v[196:199], v[56:71]
    s_waitcnt lgkmcnt(0)
    v_mfma_f32_32x32x16_bf16 v[72:87], v[116:119], v[196:199], v[72:87]
    s_waitcnt vmcnt(4)
    s_barrier
    s_mov_b32 s42, 32768
    s_add_u32 m0, s42, s43
    s_add_u32 s42, s42, 16384
    buffer_load_dwordx4 v9, s[12:15], s45 offen offset:0 nt lds
    buffer_load_dwordx4 v9, s[12:15], s45 offen offset:1024 nt lds
    buffer_load_dwordx4 v9, s[12:15], s45 offen offset:2048 nt lds
    buffer_load_dwordx4 v9, s[12:15], s45 offen offset:3072 nt lds
    s_add_u32 s45, s45, 16384
    s_cmp_eq_u32 s42, 81920
    s_cselect_b32 s42, 0, s42
    s_mov_b32 s42, 49152
    s_add_u32 m0, s42, s43
    s_add_u32 s42, s42, 16384
    buffer_load_dwordx4 v5, s[8:11], s44 offen offset:0 nt lds
    buffer_load_dwordx4 v6, s[8:11], s44 offen offset:1024 nt lds
    buffer_load_dwordx4 v7, s[8:11], s44 offen offset:2048 nt lds
    buffer_load_dwordx4 v8, s[8:11], s44 offen offset:3072 nt lds
    s_add_u32 s44, s44, 16384
    s_cmp_eq_u32 s42, 81920
    s_cselect_b32 s42, 0, s42
L_attn_qdone:
    v_lshrrev_b32 v10, 5, v14
    v_bfe_u32 v11, v14, 2, 2
    v_lshl_add_u32 v10, v10, 3, v11
    v_lshlrev_b32 v10, 8, v10
    v_bfe_u32 v12, v14, 4, 1
    v_lshl_add_u32 v10, v12, 5, v10
    v_bfe_u32 v12, v14, 1, 1
    v_and_b32 v13, 1, v14
    v_lshl_add_u32 v10, v12, 4, v10
    v_lshl_add_u32 v10, v13, 3, v10
    v_add_u32 v10, 32768, v10
    v_xor_b32 v12, 0, v11
    v_lshl_add_u32 v1, v12, 6, v10
    v_xor_b32 v12, 1, v11
    v_lshl_add_u32 v2, v12, 6, v10
    v_xor_b32 v12, 2, v11
    v_lshl_add_u32 v3, v12, 6, v10
    v_xor_b32 v12, 3, v11
    v_lshl_add_u32 v4, v12, 6, v10
    v_and_b32 v10, 0x13, v14
    v_bfe_u32 v11, v14, 2, 1
    v_lshl_or_b32 v10, v11, 3, v10
    v_bfe_u32 v11, v14, 3, 1
    v_lshl_or_b32 v10, v11, 2, v10
    v_and_b32 v11, 15, v10
    v_lshrrev_b32 v12, 5, v14
    v_xor_b32 v11, v11, v12
    v_lshlrev_b32 v10, 8, v10
    v_add_u32 v10, 0, v10
    v_xor_b32 v12, 0, v11
    v_lshl_add_u32 v232, v12, 4, v10
    v_xor_b32 v12, 2, v11
    v_lshl_add_u32 v233, v12, 4, v10
    v_xor_b32 v12, 4, v11
    v_lshl_add_u32 v234, v12, 4, v10
    v_xor_b32 v12, 6, v11
    v_lshl_add_u32 v235, v12, 4, v10
    v_xor_b32 v12, 8, v11
    v_lshl_add_u32 v236, v12, 4, v10
    v_xor_b32 v12, 10, v11
    v_lshl_add_u32 v237, v12, 4, v10
    v_xor_b32 v12, 12, v11
    v_lshl_add_u32 v238, v12, 4, v10
    v_xor_b32 v12, 14, v11
    v_lshl_add_u32 v239, v12, 4, v10
    v_bfe_u32 v10, v14, 4, 1
    v_lshl_add_u32 v10, s50, 1, v10
    v_lshlrev_b32 v10, 17, v10
    v_and_b32 v11, 15, v14
    v_lshrrev_b32 v12, 5, v14
    v_lshl_add_u32 v11, v12, 4, v11
    v_lshl_add_u32 v23, v11, 4, v10
    v_mul_f32 v24, s48, v24
    v_mul_f32 v25, s48, v25
    v_mul_f32 v26, s48, v26
    v_mul_f32 v27, s48, v27
    v_mul_f32 v28, s48, v28
    v_mul_f32 v29, s48, v29
    v_mul_f32 v30, s48, v30
    v_mul_f32 v31, s48, v31
    v_mul_f32 v32, s48, v32
    v_mul_f32 v33, s48, v33
    v_mul_f32 v34, s48, v34
    v_mul_f32 v35, s48, v35
    v_mul_f32 v36, s48, v36
    v_mul_f32 v37, s48, v37
    v_mul_f32 v38, s48, v38
    v_mul_f32 v39, s48, v39
    v_mul_f32 v40, s48, v40
    v_mul_f32 v41, s48, v41
    v_mul_f32 v42, s48, v42
    v_mul_f32 v43, s48, v43
    v_mul_f32 v44, s48, v44
    v_mul_f32 v45, s48, v45
    v_mul_f32 v46, s48, v46
    v_mul_f32 v47, s48, v47
    v_mul_f32 v48, s48, v48
    v_mul_f32 v49, s48, v49
    v_mul_f32 v50, s48, v50
    v_mul_f32 v51, s48, v51
    v_mul_f32 v52, s48, v52
    v_mul_f32 v53, s48, v53
    v_mul_f32 v54, s48, v54
    v_mul_f32 v55, s48, v55
    v_mul_f32 v56, s48, v56
    v_mul_f32 v57, s48, v57
    v_mul_f32 v58, s48, v58
    v_mul_f32 v59, s48, v59
    v_mul_f32 v60, s48, v60
    v_mul_f32 v61, s48, v61
    v_mul_f32 v62, s48, v62
    v_mul_f32 v63, s48, v63
    v_mul_f32 v64, s48, v64
    v_mul_f32 v65, s48, v65
    v_mul_f32 v66, s48, v66
    v_mul_f32 v67, s48, v67
    v_mul_f32 v68, s48, v68
    v_mul_f32 v69, s48, v69
    v_mul_f32 v70, s48, v70
    v_mul_f32 v71, s48, v71
    v_mul_f32 v72, s48, v72
    v_mul_f32 v73, s48, v73
    v_mul_f32 v74, s48, v74
    v_mul_f32 v75, s48, v75
    v_mul_f32 v76, s48, v76
    v_mul_f32 v77, s48, v77
    v_mul_f32 v78, s48, v78
    v_mul_f32 v79, s48, v79
    v_mul_f32 v80, s48, v80
    v_mul_f32 v81, s48, v81
    v_mul_f32 v82, s48, v82
    v_mul_f32 v83, s48, v83
    v_mul_f32 v84, s48, v84
    v_mul_f32 v85, s48, v85
    v_mul_f32 v86, s48, v86
    v_mul_f32 v87, s48, v87
    v_cvt_pk_bf16_f32 v88, v24, v25
    v_cvt_pk_bf16_f32 v89, v26, v27
    v_cvt_pk_bf16_f32 v90, v28, v29
    v_cvt_pk_bf16_f32 v91, v30, v31
    v_cvt_pk_bf16_f32 v92, v32, v33
    v_cvt_pk_bf16_f32 v93, v34, v35
    v_cvt_pk_bf16_f32 v94, v36, v37
    v_cvt_pk_bf16_f32 v95, v38, v39
    v_cvt_pk_bf16_f32 v96, v40, v41
    v_cvt_pk_bf16_f32 v97, v42, v43
    v_cvt_pk_bf16_f32 v98, v44, v45
    v_cvt_pk_bf16_f32 v99, v46, v47
    v_cvt_pk_bf16_f32 v100, v48, v49
    v_cvt_pk_bf16_f32 v101, v50, v51
    v_cvt_pk_bf16_f32 v102, v52, v53
    v_cvt_pk_bf16_f32 v103, v54, v55
    v_cvt_pk_bf16_f32 v104, v56, v57
    v_cvt_pk_bf16_f32 v105, v58, v59
    v_cvt_pk_bf16_f32 v106, v60, v61
    v_cvt_pk_bf16_f32 v107, v62, v63
    v_cvt_pk_bf16_f32 v108, v64, v65
    v_cvt_pk_bf16_f32 v109, v66, v67
    v_cvt_pk_bf16_f32 v110, v68, v69
    v_cvt_pk_bf16_f32 v111, v70, v71
    v_cvt_pk_bf16_f32 v112, v72, v73
    v_cvt_pk_bf16_f32 v113, v74, v75
    v_cvt_pk_bf16_f32 v114, v76, v77
    v_cvt_pk_bf16_f32 v115, v78, v79
    v_cvt_pk_bf16_f32 v116, v80, v81
    v_cvt_pk_bf16_f32 v117, v82, v83
    v_cvt_pk_bf16_f32 v118, v84, v85
    v_cvt_pk_bf16_f32 v119, v86, v87
    v_mov_b32 v24, 0
    v_mov_b32 v25, 0
    v_mov_b32 v26, 0
    v_mov_b32 v27, 0
    v_mov_b32 v28, 0
    v_mov_b32 v29, 0
    v_mov_b32 v30, 0
    v_mov_b32 v31, 0
    v_mov_b32 v32, 0
    v_mov_b32 v33, 0
    v_mov_b32 v34, 0
    v_mov_b32 v35, 0
    v_mov_b32 v36, 0
    v_mov_b32 v37, 0
    v_mov_b32 v38, 0
    v_mov_b32 v39, 0
    v_mov_b32 v40, 0
    v_mov_b32 v41, 0
    v_mov_b32 v42, 0
    v_mov_b32 v43, 0
    v_mov_b32 v44, 0
    v_mov_b32 v45, 0
    v_mov_b32 v46, 0
    v_mov_b32 v47, 0
    v_mov_b32 v48, 0
    v_mov_b32 v49, 0
    v_mov_b32 v50, 0
    v_mov_b32 v51, 0
    v_mov_b32 v52, 0
    v_mov_b32 v53, 0
    v_mov_b32 v54, 0
    v_mov_b32 v55, 0
    v_mov_b32 v56, 0
    v_mov_b32 v57, 0
    v_mov_b32 v58, 0
    v_mov_b32 v59, 0
    v_mov_b32 v60, 0
    v_mov_b32 v61, 0
    v_mov_b32 v62, 0
    v_mov_b32 v63, 0
    v_mov_b32 v64, 0
    v_mov_b32 v65, 0
    v_mov_b32 v66, 0
    v_mov_b32 v67, 0
    v_mov_b32 v68, 0
    v_mov_b32 v69, 0
    v_mov_b32 v70, 0
    v_mov_b32 v71, 0
    v_mov_b32 v72, 0
    v_mov_b32 v73, 0
    v_mov_b32 v74, 0
    v_mov_b32 v75, 0
    v_mov_b32 v76, 0
    v_mov_b32 v77, 0
    v_mov_b32 v78, 0
    v_mov_b32 v79, 0
    v_mov_b32 v80, 0
    v_mov_b32 v81, 0
    v_mov_b32 v82, 0
    v_mov_b32 v83, 0
    v_mov_b32 v84, 0
    v_mov_b32 v85, 0
    v_mov_b32 v86, 0
    v_mov_b32 v87, 0
    s_mov_b32 s95, 0
    s_mov_b32 s48, 0x41000000
    v_mov_b32 v16, 0
    s_mov_b32 s47, 0
    s_mov_b32 s54, 0
    s_mov_b32 s55, 32768
    ds_read_b128 v[200:203], v232 offset:0
    ds_read_b128 v[204:207], v233 offset:0
    ds_read_b128 v[208:211], v234 offset:0
    s_waitcnt lgkmcnt(2)
    v_mfma_f32_32x32x16_bf16 v[120:135], v[200:203], v[88:91], 0
    ds_read_b128 v[212:215], v235 offset:0
    s_waitcnt lgkmcnt(2)
    v_mfma_f32_32x32x16_bf16 v[120:135], v[204:207], v[92:95], v[120:135]
    ds_read_b128 v[200:203], v236 offset:0
    s_waitcnt lgkmcnt(2)
    v_mfma_f32_32x32x16_bf16 v[120:135], v[208:211], v[96:99], v[120:135]
    ds_read_b128 v[204:207], v237 offset:0
    s_waitcnt lgkmcnt(2)
    v_mfma_f32_32x32x16_bf16 v[120:135], v[212:215], v[100:103], v[120:135]
    ds_read_b128 v[208:211], v238 offset:0
    s_waitcnt lgkmcnt(2)
    v_mfma_f32_32x32x16_bf16 v[120:135], v[200:203], v[104:107], v[120:135]
    ds_read_b128 v[212:215], v239 offset:0
    s_waitcnt lgkmcnt(2)
    v_mfma_f32_32x32x16_bf16 v[120:135], v[204:207], v[108:111], v[120:135]
    ds_read_b128 v[200:203], v232 offset:8192
    s_waitcnt lgkmcnt(2)
    v_mfma_f32_32x32x16_bf16 v[120:135], v[208:211], v[112:115], v[120:135]
    ds_read_b128 v[204:207], v233 offset:8192
    s_waitcnt lgkmcnt(2)
    v_mfma_f32_32x32x16_bf16 v[120:135], v[212:215], v[116:119], v[120:135]
    ds_read_b128 v[208:211], v234 offset:8192
    s_waitcnt lgkmcnt(2)
    v_mfma_f32_32x32x16_bf16 v[136:151], v[200:203], v[88:91], 0
    ds_read_b128 v[212:215], v235 offset:8192
    s_waitcnt lgkmcnt(2)
    v_mfma_f32_32x32x16_bf16 v[136:151], v[204:207], v[92:95], v[136:151]
    ds_read_b128 v[200:203], v236 offset:8192
    s_waitcnt lgkmcnt(2)
    v_mfma_f32_32x32x16_bf16 v[136:151], v[208:211], v[96:99], v[136:151]
    ds_read_b128 v[204:207], v237 offset:8192
    s_waitcnt lgkmcnt(2)
    v_mfma_f32_32x32x16_bf16 v[136:151], v[212:215], v[100:103], v[136:151]
    ds_read_b128 v[208:211], v238 offset:8192
    s_waitcnt lgkmcnt(2)
    v_mfma_f32_32x32x16_bf16 v[136:151], v[200:203], v[104:107], v[136:151]
    ds_read_b128 v[212:215], v239 offset:8192
    s_waitcnt lgkmcnt(2)
    v_mfma_f32_32x32x16_bf16 v[136:151], v[204:207], v[108:111], v[136:151]
    s_waitcnt lgkmcnt(1)
    v_mfma_f32_32x32x16_bf16 v[136:151], v[208:211], v[112:115], v[136:151]
    s_waitcnt lgkmcnt(0)
    v_mfma_f32_32x32x16_bf16 v[136:151], v[212:215], v[116:119], v[136:151]
    v_add_u32 v232, 16384, v232
    v_add_u32 v233, 16384, v233
    v_add_u32 v234, 16384, v234
    v_add_u32 v235, 16384, v235
    v_add_u32 v236, 16384, v236
    v_add_u32 v237, 16384, v237
    v_add_u32 v238, 16384, v238
    v_add_u32 v239, 16384, v239
    s_mov_b32 s54, 16384
    s_nop 3
    v_max3_f32 v19, v120, v121, v122
    v_max3_f32 v20, v123, v124, v125
    v_max3_f32 v19, v19, v126, v127
    v_max3_f32 v20, v20, v128, v129
    v_max3_f32 v19, v19, v130, v131
    v_max3_f32 v20, v20, v132, v133
    v_max3_f32 v19, v19, v134, v135
    v_max3_f32 v20, v20, v136, v137
    v_max3_f32 v19, v19, v138, v139
    v_max3_f32 v20, v20, v140, v141
    v_max3_f32 v19, v19, v142, v143
    v_max3_f32 v20, v20, v144, v145
    v_max3_f32 v19, v19, v146, v147
    v_max3_f32 v20, v20, v148, v149
    v_max3_f32 v19, v19, v150, v151
    v_max_f32 v19, v19, v20
    v_mov_b32 v20, v19
    s_nop 1
    v_permlane32_swap_b32 v19, v20
    v_max_f32 v19, v19, v20
    v_sub_f32 v120, v120, v19
    v_sub_f32 v121, v121, v19
    v_sub_f32 v122, v122, v19
    v_sub_f32 v123, v123, v19
    v_sub_f32 v124, v124, v19
    v_sub_f32 v125, v125, v19
    v_sub_f32 v126, v126, v19
    v_sub_f32 v127, v127, v19
    v_sub_f32 v128, v128, v19
    v_sub_f32 v129, v129, v19
    v_sub_f32 v130, v130, v19
    v_sub_f32 v131, v131, v19
    v_sub_f32 v132, v132, v19
    v_sub_f32 v133, v133, v19
    v_sub_f32 v134, v134, v19
    v_sub_f32 v135, v135, v19
    v_sub_f32 v136, v136, v19
    v_sub_f32 v137, v137, v19
    v_sub_f32 v138, v138, v19
    v_sub_f32 v139, v139, v19
    v_sub_f32 v140, v140, v19
    v_sub_f32 v141, v141, v19
    v_sub_f32 v142, v142, v19
    v_sub_f32 v143, v143, v19
    v_sub_f32 v144, v144, v19
    v_sub_f32 v145, v145, v19
    v_sub_f32 v146, v146, v19
    v_sub_f32 v147, v147, v19
    v_sub_f32 v148, v148, v19
    v_sub_f32 v149, v149, v19
    v_sub_f32 v150, v150, v19
    v_sub_f32 v151, v151, v19
    v_sub_f32 v240, 0, v19
    v_sub_f32 v241, 0, v19
    v_sub_f32 v242, 0, v19
    v_sub_f32 v243, 0, v19
    v_sub_f32 v244, 0, v19
    v_sub_f32 v245, 0, v19
    v_sub_f32 v246, 0, v19
    v_sub_f32 v247, 0, v19
    v_sub_f32 v248, 0, v19
    v_sub_f32 v249, 0, v19
    v_sub_f32 v250, 0, v19
    v_sub_f32 v251, 0, v19
    v_sub_f32 v252, 0, v19
    v_sub_f32 v253, 0, v19
    v_sub_f32 v254, 0, v19
    v_sub_f32 v255, 0, v19
    v_exp_f32 v120, v120
    v_exp_f32 v121, v121
    v_exp_f32 v122, v122
    v_exp_f32 v123, v123
    v_exp_f32 v124, v124
    v_exp_f32 v125, v125
    v_exp_f32 v126, v126
    v_exp_f32 v127, v127
    v_exp_f32 v128, v128
    v_exp_f32 v129, v129
    v_exp_f32 v130, v130
    v_exp_f32 v131, v131
    v_exp_f32 v132, v132
    v_exp_f32 v133, v133
    v_exp_f32 v134, v134
    v_exp_f32 v135, v135
    v_exp_f32 v136, v136
    v_exp_f32 v137, v137
    v_exp_f32 v138, v138
    v_exp_f32 v139, v139
L_attn_loop:
    s_waitcnt vmcnt(4)
    s_barrier
    ds_read_b128 v[200:203], v232 offset:0
    ds_read_b128 v[204:207], v233 offset:0
    ds_read_b128 v[208:211], v234 offset:0
    v_exp_f32 v140, v140
    v_exp_f32 v141, v141
    v_exp_f32 v142, v142
    v_exp_f32 v143, v143
    v_exp_f32 v144, v144
    v_exp_f32 v145, v145
    s_add_u32 s49, s54, 32768
    s_cmp_ge_u32 s49, 81920
    s_cselect_b32 s52, 81920, 0
    s_sub_u32 s49, s49, s52
    s_sub_u32 s52, s49, s54
    s_mov_b32 s54, s49
    s_mov_b32 s49, s52
    s_add_u32 s51, s55, 32768
    s_cmp_ge_u32 s51, 81920
    s_cselect_b32 s52, 81920, 0
    s_sub_u32 s51, s51, s52
    s_sub_u32 s52, s51, s55
    s_mov_b32 s55, s51
    s_mov_b32 s51, s52
    s_waitcnt lgkmcnt(2)
    v_mfma_f32_32x32x16_bf16 v[152:167], v[200:203], v[88:91], v[240:255]
    ds_read_b128 v[212:215], v235 offset:0
    s_add_u32 m0, s42, s43
    s_add_u32 s42, s42, 16384
    buffer_load_dwordx4 v9, s[12:15], s45 offen offset:0 nt lds
    v_exp_f32 v146, v146
    v_exp_f32 v147, v147
    s_waitcnt lgkmcnt(2)
    v_mfma_f32_32x32x16_bf16 v[152:167], v[204:207], v[92:95], v[152:167]
    ds_read_b128 v[200:203], v236 offset:0
    v_exp_f32 v148, v148
    v_exp_f32 v149, v149
    s_waitcnt lgkmcnt(2)
    v_mfma_f32_32x32x16_bf16 v[152:167], v[208:211], v[96:99], v[152:167]
    ds_read_b128 v[204:207], v237 offset:0
    s_cmp_lg_u32 s95, 0
    s_cbranch_scc1 L_rs_0
L_rsback_0:
    buffer_load_dwordx4 v9, s[12:15], s45 offen offset:1024 nt lds
    v_exp_f32 v150, v150
    v_exp_f32 v151, v151
    s_waitcnt lgkmcnt(2)
    v_mfma_f32_32x32x16_bf16 v[152:167], v[212:215], v[100:103], v[152:167]
    ds_read_b128 v[208:211], v238 offset:0
    v_add_f32 v19, v120, v121
    v_add_f32 v20, v122, v123
    v_add_f32 v21, v124, v125
    s_waitcnt lgkmcnt(2)
    v_mfma_f32_32x32x16_bf16 v[152:167], v[200:203], v[104:107], v[152:167]
    ds_read_b128 v[212:215], v239 offset:0
    buffer_load_dwordx4 v9, s[12:15], s45 offen offset:2048 nt lds
    v_add_f32 v22, v126, v127
    v_add_f32 v19, v19, v128
    v_add_f32 v20, v20, v129
    v_add_f32 v21, v21, v130
    s_waitcnt lgkmcnt(2)
    v_mfma_f32_32x32x16_bf16 v[152:167], v[204:207], v[108:111], v[152:167]
    ds_read_b128 v[200:203], v232 offset:8192
    v_add_f32 v22, v22, v131
    v_add_f32 v19, v19, v132
    v_add_f32 v20, v20, v133
    v_add_f32 v21, v21, v134
    s_waitcnt lgkmcnt(2)
    v_mfma_f32_32x32x16_bf16 v[152:167], v[208:211], v[112:115], v[152:167]
    ds_read_b128 v[204:207], v233 offset:8192
    buffer_load_dwordx4 v9, s[12:15], s45 offen offset:3072 nt lds
    s_add_u32 s45, s45, 16384
    s_cmp_eq_u32 s42, 81920
    s_cselect_b32 s42, 0, s42
    v_add_f32 v22, v22, v135
    v_add_f32 v19, v19, v136
    v_add_f32 v20, v20, v137
    s_waitcnt lgkmcnt(2)
    v_mfma_f32_32x32x16_bf16 v[152:167], v[212:215], v[116:119], v[152:167]
    ds_read_b128 v[208:211], v234 offset:8192
    v_add_f32 v21, v21, v138
    v_add_f32 v22, v22, v139
    v_add_f32 v19, v19, v140
    v_add_f32 v20, v20, v141
    s_waitcnt lgkmcnt(2)
    v_mfma_f32_32x32x16_bf16 v[168:183], v[200:203], v[88:91], v[240:255]
    ds_read_b128 v[212:215], v235 offset:8192
    s_add_u32 m0, s42, s43
    s_add_u32 s42, s42, 16384
    buffer_load_dwordx4 v5, s[8:11], s44 offen offset:0 nt lds
    v_add_f32 v21, v21, v142
    v_add_f32 v22, v22, v143
    v_add_f32 v19, v19, v144
    v_add_f32 v20, v20, v145
    s_waitcnt lgkmcnt(2)
    v_mfma_f32_32x32x16_bf16 v[168:183], v[204:207], v[92:95], v[168:183]
    ds_read_b128 v[200:203], v236 offset:8192
    v_add_f32 v21, v21, v146
    v_add_f32 v22, v22, v147
    v_add_f32 v19, v19, v148
    v_add_f32 v20, v20, v149
    s_waitcnt lgkmcnt(2)
    v_mfma_f32_32x32x16_bf16 v[168:183], v[208:211], v[96:99], v[168:183]
    ds_read_b128 v[204:207], v237 offset:8192
    buffer_load_dwordx4 v6, s[8:11], s44 offen offset:1024 nt lds
    v_add_f32 v21, v21, v150
    v_add_f32 v22, v22, v151
    v_cvt_pk_bf16_f32 v184, v120, v121
    s_waitcnt lgkmcnt(2)
    v_mfma_f32_32x32x16_bf16 v[168:183], v[212:215], v[100:103], v[168:183]
    ds_read_b128 v[208:211], v238 offset:8192
    v_cvt_pk_bf16_f32 v185, v122, v123
    v_cvt_pk_bf16_f32 v186, v124, v125
    v_cvt_pk_bf16_f32 v187, v126, v127
    v_cvt_pk_bf16_f32 v188, v128, v129
    s_waitcnt lgkmcnt(2)
    v_mfma_f32_32x32x16_bf16 v[168:183], v[200:203], v[104:107], v[168:183]
    ds_read_b128 v[212:215], v239 offset:8192
    buffer_load_dwordx4 v7, s[8:11], s44 offen offset:2048 nt lds
    v_add_u32 v232, s49, v232
    v_add_u32 v233, s49, v233
    v_add_u32 v234, s49, v234
    v_add_u32 v235, s49, v235
    v_add_u32 v236, s49, v236
    v_add_u32 v237, s49, v237
    v_add_u32 v238, s49, v238
    v_add_u32 v239, s49, v239
    v_cvt_pk_bf16_f32 v189, v130, v131
    v_cvt_pk_bf16_f32 v190, v132, v133
    v_cvt_pk_bf16_f32 v191, v134, v135
    v_cvt_pk_bf16_f32 v192, v136, v137
    s_waitcnt lgkmcnt(2)
    v_mfma_f32_32x32x16_bf16 v[168:183], v[204:207], v[108:111], v[168:183]
    ds_read_b64_tr_b16 v[216:217], v1 offset:0
    ds_read_b64_tr_b16 v[218:219], v1 offset:1024
    v_cvt_pk_bf16_f32 v193, v138, v139
    v_cvt_pk_bf16_f32 v194, v140, v141
    v_cvt_pk_bf16_f32 v195, v142, v143
    v_cvt_pk_bf16_f32 v196, v144, v145
    s_waitcnt lgkmcnt(3)
    v_mfma_f32_32x32x16_bf16 v[168:183], v[208:211], v[112:115], v[168:183]
    buffer_load_dwordx4 v8, s[8:11], s44 offen offset:3072 nt lds
    s_add_u32 s44, s44, 16384
    s_cmp_eq_u32 s42, 81920
    s_cselect_b32 s42, 0, s42
    ds_read_b64_tr_b16 v[220:221], v2 offset:0
    ds_read_b64_tr_b16 v[222:223], v2 offset:1024
    v_cvt_pk_bf16_f32 v197, v146, v147
    v_cvt_pk_bf16_f32 v198, v148, v149
    v_cvt_pk_bf16_f32 v199, v150, v151
    s_waitcnt lgkmcnt(4)
    v_mfma_f32_32x32x16_bf16 v[168:183], v[212:215], v[116:119], v[168:183]
    ds_read_b64_tr_b16 v[224:225], v3 offset:0
    ds_read_b64_tr_b16 v[226:227], v3 offset:1024
    v_add_f32 v19, v19, v20
    v_add_f32 v21, v21, v22
    v_add_f32 v16, v16, v19
    v_add_f32 v16, v16, v21
    s_waitcnt lgkmcnt(4)
    v_mfma_f32_32x32x16_bf16 v[24:39], v[216:219], v[184:187], v[24:39]
    ds_read_b64_tr_b16 v[228:229], v4 offset:0
    ds_read_b64_tr_b16 v[230:231], v4 offset:1024
    v_max3_f32 v19, v152, v153, v154
    v_max3_f32 v20, v155, v156, v157
    v_max3_f32 v19, v19, v158, v159
    v_max3_f32 v20, v20, v160, v161
    v_max3_f32 v19, v19, v162, v163
    v_max3_f32 v20, v20, v164, v165
    v_max3_f32 v19, v19, v166, v167
    s_waitcnt lgkmcnt(4)
    v_mfma_f32_32x32x16_bf16 v[40:55], v[220:223], v[184:187], v[40:55]
    ds_read_b64_tr_b16 v[216:217], v1 offset:4096
    ds_read_b64_tr_b16 v[218:219], v1 offset:5120
    s_waitcnt lgkmcnt(4)
    v_mfma_f32_32x32x16_bf16 v[56:71], v[224:227], v[184:187], v[56:71]
    ds_read_b64_tr_b16 v[220:221], v2 offset:4096
    ds_read_b64_tr_b16 v[222:223], v2 offset:5120
    v_max3_f32 v20, v20, v168, v169
    v_max3_f32 v19, v19, v170, v171
    v_max3_f32 v20, v20, v172, v173
    v_max3_f32 v19, v19, v174, v175
    s_waitcnt lgkmcnt(4)
    v_mfma_f32_32x32x16_bf16 v[72:87], v[228:231], v[184:187], v[72:87]
    ds_read_b64_tr_b16 v[224:225], v3 offset:4096
    ds_read_b64_tr_b16 v[226:227], v3 offset:5120
    v_max3_f32 v20, v20, v176, v177
    v_max3_f32 v19, v19, v178, v179
    v_max3_f32 v20, v20, v180, v181
    v_max3_f32 v19, v19, v182, v183
    s_waitcnt lgkmcnt(4)
    v_mfma_f32_32x32x16_bf16 v[24:39], v[216:219], v[188:191], v[24:39]
    ds_read_b64_tr_b16 v[228:229], v4 offset:4096
    ds_read_b64_tr_b16 v[230:231], v4 offset:5120
    v_max_f32 v19, v19, v20
    v_mov_b32 v20, v19
    s_nop 1
    v_permlane32_swap_b32 v19, v20
    s_waitcnt lgkmcnt(4)
    v_mfma_f32_32x32x16_bf16 v[40:55], v[220:223], v[188:191], v[40:55]
    ds_read_b64_tr_b16 v[216:217], v1 offset:8192
    ds_read_b64_tr_b16 v[218:219], v1 offset:9216
    v_max_f32 v19, v19, v20
    v_cmp_lt_f32 vcc, s48, v19
    s_cbranch_vccnz L_slow_0
L_back_0:
    s_waitcnt lgkmcnt(4)
    v_mfma_f32_32x32x16_bf16 v[56:71], v[224:227], v[188:191], v[56:71]
    ds_read_b64_tr_b16 v[220:221], v2 offset:8192
    ds_read_b64_tr_b16 v[222:223], v2 offset:9216
    v_exp_f32 v152, v152
    v_exp_f32 v153, v153
    s_waitcnt lgkmcnt(4)
    v_mfma_f32_32x32x16_bf16 v[72:87], v[228:231], v[188:191], v[72:87]
    ds_read_b64_tr_b16 v[224:225], v3 offset:8192
    ds_read_b64_tr_b16 v[226:227], v3 offset:9216
    v_exp_f32 v154, v154
    v_exp_f32 v155, v155
    s_waitcnt lgkmcnt(4)
    v_mfma_f32_32x32x16_bf16 v[24:39], v[216:219], v[192:195], v[24:39]
    ds_read_b64_tr_b16 v[228:229], v4 offset:8192
    ds_read_b64_tr_b16 v[230:231], v4 offset:9216
    v_exp_f32 v156, v156
    v_exp_f32 v157, v157
    s_waitcnt lgkmcnt(4)
    v_mfma_f32_32x32x16_bf16 v[40:55], v[220:223], v[192:195], v[40:55]
    ds_read_b64_tr_b16 v[216:217], v1 offset:12288
    ds_read_b64_tr_b16 v[218:219], v1 offset:13312
    v_exp_f32 v158, v158
    v_exp_f32 v159, v159
    s_waitcnt lgkmcnt(4)
    v_mfma_f32_32x32x16_bf16 v[56:71], v[224:227], v[192:195], v[56:71]
    ds_read_b64_tr_b16 v[220:221], v2 offset:12288
    ds_read_b64_tr_b16 v[222:223], v2 offset:13312
    v_exp_f32 v160, v160
    v_exp_f32 v161, v161
    s_waitcnt lgkmcnt(4)
    v_mfma_f32_32x32x16_bf16 v[72:87], v[228:231], v[192:195], v[72:87]
    ds_read_b64_tr_b16 v[224:225], v3 offset:12288
    ds_read_b64_tr_b16 v[226:227], v3 offset:13312
    v_exp_f32 v162, v162
    v_exp_f32 v163, v163
    s_waitcnt lgkmcnt(4)
    v_mfma_f32_32x32x16_bf16 v[24:39], v[216:219], v[196:199], v[24:39]
    ds_read_b64_tr_b16 v[228:229], v4 offset:12288
    ds_read_b64_tr_b16 v[230:231], v4 offset:13312
    v_add_u32 v1, s51, v1
    v_add_u32 v2, s51, v2
    v_add_u32 v3, s51, v3
    v_add_u32 v4, s51, v4
    v_exp_f32 v164, v164
    v_exp_f32 v165, v165
    s_waitcnt lgkmcnt(4)
    v_mfma_f32_32x32x16_bf16 v[40:55], v[220:223], v[196:199], v[40:55]
    v_exp_f32 v166, v166
    v_exp_f32 v167, v167
    s_waitcnt lgkmcnt(2)
    v_mfma_f32_32x32x16_bf16 v[56:71], v[224:227], v[196:199], v[56:71]
    v_exp_f32 v168, v168
    v_exp_f32 v169, v169
    s_waitcnt lgkmcnt(0)
    v_mfma_f32_32x32x16_bf16 v[72:87], v[228:231], v[196:199], v[72:87]
    v_exp_f32 v170, v170
    v_exp_f32 v171, v171
    s_waitcnt vmcnt(4)
    s_barrier
    ds_read_b128 v[200:203], v232 offset:0
    ds_read_b128 v[204:207], v233 offset:0
    ds_read_b128 v[208:211], v234 offset:0
    v_exp_f32 v172, v172
    v_exp_f32 v173, v173
    v_exp_f32 v174, v174
    v_exp_f32 v175, v175
    v_exp_f32 v176, v176
    v_exp_f32 v177, v177
    s_add_u32 s49, s54, 32768
    s_cmp_ge_u32 s49, 81920
    s_cselect_b32 s52, 81920, 0
    s_sub_u32 s49, s49, s52
    s_sub_u32 s52, s49, s54
    s_mov_b32 s54, s49
    s_mov_b32 s49, s52
    s_add_u32 s51, s55, 32768
    s_cmp_ge_u32 s51, 81920
    s_cselect_b32 s52, 81920, 0
    s_sub_u32 s51, s51, s52
    s_sub_u32 s52, s51, s55
    s_mov_b32 s55, s51
    s_mov_b32 s51, s52
    s_waitcnt lgkmcnt(2)
    v_mfma_f32_32x32x16_bf16 v[120:135], v[200:203], v[88:91], v[240:255]
    ds_read_b128 v[212:215], v235 offset:0
    s_add_u32 m0, s42, s43
    s_add_u32 s42, s42, 16384
    buffer_load_dwordx4 v9, s[12:15], s45 offen offset:0 nt lds
    v_exp_f32 v178, v178
    v_exp_f32 v179, v179
    s_waitcnt lgkmcnt(2)
    v_mfma_f32_32x32x16_bf16 v[120:135], v[204:207], v[92:95], v[120:135]
    ds_read_b128 v[200:203], v236 offset:0
    v_exp_f32 v180, v180
    v_exp_f32 v181, v181
    s_waitcnt lgkmcnt(2)
    v_mfma_f32_32x32x16_bf16 v[120:135], v[208:211], v[96:99], v[120:135]
    ds_read_b128 v[204:207], v237 offset:0
    s_cmp_lg_u32 s95, 0
    s_cbranch_scc1 L_rs_1
L_rsback_1:
    buffer_load_dwordx4 v9, s[12:15], s45 offen offset:1024 nt lds
    v_exp_f32 v182, v182
    v_exp_f32 v183, v183
    s_waitcnt lgkmcnt(2)
    v_mfma_f32_32x32x16_bf16 v[120:135], v[212:215], v[100:103], v[120:135]
    ds_read_b128 v[208:211], v238 offset:0
    v_add_f32 v19, v152, v153
    v_add_f32 v20, v154, v155
    v_add_f32 v21, v156, v157
    s_waitcnt lgkmcnt(2)
    v_mfma_f32_32x32x16_bf16 v[120:135], v[200:203], v[104:107], v[120:135]
    ds_read_b128 v[212:215], v239 offset:0
    buffer_load_dwordx4 v9, s[12:15], s45 offen offset:2048 nt lds
    v_add_f32 v22, v158, v159
    v_add_f32 v19, v19, v160
    v_add_f32 v20, v20, v161
    v_add_f32 v21, v21, v162
    s_waitcnt lgkmcnt(2)
    v_mfma_f32_32x32x16_bf16 v[120:135], v[204:207], v[108:111], v[120:135]
    ds_read_b128 v[200:203], v232 offset:8192
    v_add_f32 v22, v22, v163
    v_add_f32 v19, v19, v164
    v_add_f32 v20, v20, v165
    v_add_f32 v21, v21, v166
    s_waitcnt lgkmcnt(2)
    v_mfma_f32_32x32x16_bf16 v[120:135], v[208:211], v[112:115], v[120:135]
    ds_read_b128 v[204:207], v233 offset:8192
    buffer_load_dwordx4 v9, s[12:15], s45 offen offset:3072 nt lds
    s_add_u32 s45, s45, 16384
    s_cmp_eq_u32 s42, 81920
    s_cselect_b32 s42, 0, s42
    v_add_f32 v22, v22, v167
    v_add_f32 v19, v19, v168
    v_add_f32 v20, v20, v169
    s_waitcnt lgkmcnt(2)
    v_mfma_f32_32x32x16_bf16 v[120:135], v[212:215], v[116:119], v[120:135]
    ds_read_b128 v[208:211], v234 offset:8192
    v_add_f32 v21, v21, v170
    v_add_f32 v22, v22, v171
    v_add_f32 v19, v19, v172
    v_add_f32 v20, v20, v173
    s_waitcnt lgkmcnt(2)
    v_mfma_f32_32x32x16_bf16 v[136:151], v[200:203], v[88:91], v[240:255]
    ds_read_b128 v[212:215], v235 offset:8192
    s_add_u32 m0, s42, s43
    s_add_u32 s42, s42, 16384
    buffer_load_dwordx4 v5, s[8:11], s44 offen offset:0 nt lds
    v_add_f32 v21, v21, v174
    v_add_f32 v22, v22, v175
    v_add_f32 v19, v19, v176
    v_add_f32 v20, v20, v177
    s_waitcnt lgkmcnt(2)
    v_mfma_f32_32x32x16_bf16 v[136:151], v[204:207], v[92:95], v[136:151]
    ds_read_b128 v[200:203], v236 offset:8192
    v_add_f32 v21, v21, v178
    v_add_f32 v22, v22, v179
    v_add_f32 v19, v19, v180
    v_add_f32 v20, v20, v181
    s_waitcnt lgkmcnt(2)
    v_mfma_f32_32x32x16_bf16 v[136:151], v[208:211], v[96:99], v[136:151]
    ds_read_b128 v[204:207], v237 offset:8192
    buffer_load_dwordx4 v6, s[8:11], s44 offen offset:1024 nt lds
    v_add_f32 v21, v21, v182
    v_add_f32 v22, v22, v183
    v_cvt_pk_bf16_f32 v184, v152, v153
    s_waitcnt lgkmcnt(2)
    v_mfma_f32_32x32x16_bf16 v[136:151], v[212:215], v[100:103], v[136:151]
    ds_read_b128 v[208:211], v238 offset:8192
    v_cvt_pk_bf16_f32 v185, v154, v155
    v_cvt_pk_bf16_f32 v186, v156, v157
    v_cvt_pk_bf16_f32 v187, v158, v159
    v_cvt_pk_bf16_f32 v188, v160, v161
    s_waitcnt lgkmcnt(2)
    v_mfma_f32_32x32x16_bf16 v[136:151], v[200:203], v[104:107], v[136:151]
    ds_read_b128 v[212:215], v239 offset:8192
    buffer_load_dwordx4 v7, s[8:11], s44 offen offset:2048 nt lds
    v_add_u32 v232, s49, v232
    v_add_u32 v233, s49, v233
    v_add_u32 v234, s49, v234
    v_add_u32 v235, s49, v235
    v_add_u32 v236, s49, v236
    v_add_u32 v237, s49, v237
    v_add_u32 v238, s49, v238
    v_add_u32 v239, s49, v239
    v_cvt_pk_bf16_f32 v189, v162, v163
    v_cvt_pk_bf16_f32 v190, v164, v165
    v_cvt_pk_bf16_f32 v191, v166, v167
    v_cvt_pk_bf16_f32 v192, v168, v169
    s_waitcnt lgkmcnt(2)
    v_mfma_f32_32x32x16_bf16 v[136:151], v[204:207], v[108:111], v[136:151]
    ds_read_b64_tr_b16 v[216:217], v1 offset:0
    ds_read_b64_tr_b16 v[218:219], v1 offset:1024
    v_cvt_pk_bf16_f32 v193, v170, v171
    v_cvt_pk_bf16_f32 v194, v172, v173
    v_cvt_pk_bf16_f32 v195, v174, v175
    v_cvt_pk_bf16_f32 v196, v176, v177
    s_waitcnt lgkmcnt(3)
    v_mfma_f32_32x32x16_bf16 v[136:151], v[208:211], v[112:115], v[136:151]
    buffer_load_dwordx4 v8, s[8:11], s44 offen offset:3072 nt lds
    s_add_u32 s44, s44, 16384
    s_cmp_eq_u32 s42, 81920
    s_cselect_b32 s42, 0, s42
    ds_read_b64_tr_b16 v[220:221], v2 offset:0
    ds_read_b64_tr_b16 v[222:223], v2 offset:1024
    v_cvt_pk_bf16_f32 v197, v178, v179
    v_cvt_pk_bf16_f32 v198, v180, v181
    v_cvt_pk_bf16_f32 v199, v182, v183
    s_waitcnt lgkmcnt(4)
    v_mfma_f32_32x32x16_bf16 v[136:151], v[212:215], v[116:119], v[136:151]
    ds_read_b64_tr_b16 v[224:225], v3 offset:0
    ds_read_b64_tr_b16 v[226:227], v3 offset:1024
    v_add_f32 v19, v19, v20
    v_add_f32 v21, v21, v22
    v_add_f32 v16, v16, v19
    v_add_f32 v16, v16, v21
    s_waitcnt lgkmcnt(4)
    v_mfma_f32_32x32x16_bf16 v[24:39], v[216:219], v[184:187], v[24:39]
    ds_read_b64_tr_b16 v[228:229], v4 offset:0
    ds_read_b64_tr_b16 v[230:231], v4 offset:1024
    v_max3_f32 v19, v120, v121, v122
    v_max3_f32 v20, v123, v124, v125
    v_max3_f32 v19, v19, v126, v127
    v_max3_f32 v20, v20, v128, v129
    v_max3_f32 v19, v19, v130, v131
    v_max3_f32 v20, v20, v132, v133
    v_max3_f32 v19, v19, v134, v135
    s_waitcnt lgkmcnt(4)
    v_mfma_f32_32x32x16_bf16 v[40:55], v[220:223], v[184:187], v[40:55]
    ds_read_b64_tr_b16 v[216:217], v1 offset:4096
    ds_read_b64_tr_b16 v[218:219], v1 offset:5120
    s_waitcnt lgkmcnt(4)
    v_mfma_f32_32x32x16_bf16 v[56:71], v[224:227], v[184:187], v[56:71]
    ds_read_b64_tr_b16 v[220:221], v2 offset:4096
    ds_read_b64_tr_b16 v[222:223], v2 offset:5120
    v_max3_f32 v20, v20, v136, v137
    v_max3_f32 v19, v19, v138, v139
    v_max3_f32 v20, v20, v140, v141
    v_max3_f32 v19, v19, v142, v143
    s_waitcnt lgkmcnt(4)
    v_mfma_f32_32x32x16_bf16 v[72:87], v[228:231], v[184:187], v[72:87]
    ds_read_b64_tr_b16 v[224:225], v3 offset:4096
    ds_read_b64_tr_b16 v[226:227], v3 offset:5120
    v_max3_f32 v20, v20, v144, v145
    v_max3_f32 v19, v19, v146, v147
    v_max3_f32 v20, v20, v148, v149
    v_max3_f32 v19, v19, v150, v151
    s_waitcnt lgkmcnt(4)
    v_mfma_f32_32x32x16_bf16 v[24:39], v[216:219], v[188:191], v[24:39]
    ds_read_b64_tr_b16 v[228:229], v4 offset:4096
    ds_read_b64_tr_b16 v[230:231], v4 offset:5120
    v_max_f32 v19, v19, v20
    v_mov_b32 v20, v19
    s_nop 1
    v_permlane32_swap_b32 v19, v20
    s_waitcnt lgkmcnt(4)
    v_mfma_f32_32x32x16_bf16 v[40:55], v[220:223], v[188:191], v[40:55]
    ds_read_b64_tr_b16 v[216:217], v1 offset:8192
    ds_read_b64_tr_b16 v[218:219], v1 offset:9216
    v_max_f32 v19, v19, v20
    v_cmp_lt_f32 vcc, s48, v19
    s_cbranch_vccnz L_slow_1
L_back_1:
    s_waitcnt lgkmcnt(4)
    v_mfma_f32_32x32x16_bf16 v[56:71], v[224:227], v[188:191], v[56:71]
    ds_read_b64_tr_b16 v[220:221], v2 offset:8192
    ds_read_b64_tr_b16 v[222:223], v2 offset:9216
    v_exp_f32 v120, v120
    v_exp_f32 v121, v121
    s_waitcnt lgkmcnt(4)
    v_mfma_f32_32x32x16_bf16 v[72:87], v[228:231], v[188:191], v[72:87]
    ds_read_b64_tr_b16 v[224:225], v3 offset:8192
    ds_read_b64_tr_b16 v[226:227], v3 offset:9216
    v_exp_f32 v122, v122
    v_exp_f32 v123, v123
    s_waitcnt lgkmcnt(4)
    v_mfma_f32_32x32x16_bf16 v[24:39], v[216:219], v[192:195], v[24:39]
    ds_read_b64_tr_b16 v[228:229], v4 offset:8192
    ds_read_b64_tr_b16 v[230:231], v4 offset:9216
    v_exp_f32 v124, v124
    v_exp_f32 v125, v125
    s_waitcnt lgkmcnt(4)
    v_mfma_f32_32x32x16_bf16 v[40:55], v[220:223], v[192:195], v[40:55]
    ds_read_b64_tr_b16 v[216:217], v1 offset:12288
    ds_read_b64_tr_b16 v[218:219], v1 offset:13312
    v_exp_f32 v126, v126
    v_exp_f32 v127, v127
    s_waitcnt lgkmcnt(4)
    v_mfma_f32_32x32x16_bf16 v[56:71], v[224:227], v[192:195], v[56:71]
    ds_read_b64_tr_b16 v[220:221], v2 offset:12288
    ds_read_b64_tr_b16 v[222:223], v2 offset:13312
    v_exp_f32 v128, v128
    v_exp_f32 v129, v129
    s_waitcnt lgkmcnt(4)
    v_mfma_f32_32x32x16_bf16 v[72:87], v[228:231], v[192:195], v[72:87]
    ds_read_b64_tr_b16 v[224:225], v3 offset:12288
    ds_read_b64_tr_b16 v[226:227], v3 offset:13312
    v_exp_f32 v130, v130
    v_exp_f32 v131, v131
    s_waitcnt lgkmcnt(4)
    v_mfma_f32_32x32x16_bf16 v[24:39], v[216:219], v[196:199], v[24:39]
    ds_read_b64_tr_b16 v[228:229], v4 offset:12288
    ds_read_b64_tr_b16 v[230:231], v4 offset:13312
    v_add_u32 v1, s51, v1
    v_add_u32 v2, s51, v2
    v_add_u32 v3, s51, v3
    v_add_u32 v4, s51, v4
    v_exp_f32 v132, v132
    v_exp_f32 v133, v133
    s_waitcnt lgkmcnt(4)
    v_mfma_f32_32x32x16_bf16 v[40:55], v[220:223], v[196:199], v[40:55]
    v_exp_f32 v134, v134
    v_exp_f32 v135, v135
    s_waitcnt lgkmcnt(2)
    v_mfma_f32_32x32x16_bf16 v[56:71], v[224:227], v[196:199], v[56:71]
    v_exp_f32 v136, v136
    v_exp_f32 v137, v137
    s_waitcnt lgkmcnt(0)
    v_mfma_f32_32x32x16_bf16 v[72:87], v[228:231], v[196:199], v[72:87]
    v_exp_f32 v138, v138
    v_exp_f32 v139, v139
    s_add_u32 s47, s47, 1
    s_cmp_lt_u32 s47, 8
    s_cbranch_scc1 L_attn_loop
    s_mul_i32 s3, s40, 40
    s_add_u32 s4, s0, s3
    s_addc_u32 s5, s1, 0
    s_load_dwordx2 s[4:5], s[4:5], 32
    s_and_b32 s3, s2, 3
    s_lshl_b32 s3, s3, 6
    s_lshr_b32 s6, s2, 3
    s_add_u32 s3, s3, s6
    s_mul_i32 s3, s3, 18432
    v_lshlrev_b32 v21, 4, v0
    s_waitcnt lgkmcnt(0)
    s_add_u32 s4, s4, s3
    s_addc_u32 s5, s5, 0
    s_mov_b32 s6, 18432
    s_mov_b32 s7, 0x20000
    s_movk_i32 s3, 0
    buffer_load_dwordx4 v[200:203], v21, s[4:7], s3 offen
    s_movk_i32 s3, 4096
    buffer_load_dwordx4 v[204:207], v21, s[4:7], s3 offen
    s_movk_i32 s3, 8192
    buffer_load_dwordx4 v[208:211], v21, s[4:7], s3 offen
    s_movk_i32 s3, 12288
    buffer_load_dwordx4 v[212:215], v21, s[4:7], s3 offen
    s_movk_i32 s3, 16384
    buffer_load_dwordx4 v[216:219], v21, s[4:7], s3 offen
    s_add_u32 s3, s2, s50
    s_cmp_eq_u32 s3, 0
    s_cbranch_scc0 L_attn_nononce
    s_memrealtime s[6:7]
    s_add_u32 s4, s36, 58720256
    s_addc_u32 s5, s37, 0
    s_waitcnt lgkmcnt(0)
    v_mov_b32 v19, s6
    v_mov_b32 v20, 0
    s_mov_b32 s6, 4
    s_mov_b32 s7, 0x20000
    buffer_store_dword v19, v20, s[4:7], 0 offen
L_attn_nononce:
    v_mov_b32 v20, v16
    s_nop 1
    v_permlane32_swap_b32 v16, v20
    v_add_f32 v16, v16, v20
    v_rcp_f32 v16, v16
    s_nop 7
    s_nop 3
    v_mul_f32 v24, v24, v16
    v_mul_f32 v25, v25, v16
    v_mul_f32 v26, v26, v16
    v_mul_f32 v27, v27, v16
    v_mul_f32 v28, v28, v16
    v_mul_f32 v29, v29, v16
    v_mul_f32 v30, v30, v16
    v_mul_f32 v31, v31, v16
    v_mul_f32 v32, v32, v16
    v_mul_f32 v33, v33, v16
    v_mul_f32 v34, v34, v16
    v_mul_f32 v35, v35, v16
    v_mul_f32 v36, v36, v16
    v_mul_f32 v37, v37, v16
    v_mul_f32 v38, v38, v16
    v_mul_f32 v39, v39, v16
    v_mul_f32 v40, v40, v16
    v_mul_f32 v41, v41, v16
    v_mul_f32 v42, v42, v16
    v_mul_f32 v43, v43, v16
    v_mul_f32 v44, v44, v16
    v_mul_f32 v45, v45, v16
    v_mul_f32 v46, v46, v16
    v_mul_f32 v47, v47, v16
    v_mul_f32 v48, v48, v16
    v_mul_f32 v49, v49, v16
    v_mul_f32 v50, v50, v16
    v_mul_f32 v51, v51, v16
    v_mul_f32 v52, v52, v16
    v_mul_f32 v53, v53, v16
    v_mul_f32 v54, v54, v16
    v_mul_f32 v55, v55, v16
    v_mul_f32 v56, v56, v16
    v_mul_f32 v57, v57, v16
    v_mul_f32 v58, v58, v16
    v_mul_f32 v59, v59, v16
    v_mul_f32 v60, v60, v16
    v_mul_f32 v61, v61, v16
    v_mul_f32 v62, v62, v16
    v_mul_f32 v63, v63, v16
    v_mul_f32 v64, v64, v16
    v_mul_f32 v65, v65, v16
    v_mul_f32 v66, v66, v16
    v_mul_f32 v67, v67, v16
    v_mul_f32 v68, v68, v16
    v_mul_f32 v69, v69, v16
    v_mul_f32 v70, v70, v16
    v_mul_f32 v71, v71, v16
    v_mul_f32 v72, v72, v16
    v_mul_f32 v73, v73, v16
    v_mul_f32 v74, v74, v16
    v_mul_f32 v75, v75, v16
    v_mul_f32 v76, v76, v16
    v_mul_f32 v77, v77, v16
    v_mul_f32 v78, v78, v16
    v_mul_f32 v79, v79, v16
    v_mul_f32 v80, v80, v16
    v_mul_f32 v81, v81, v16
    v_mul_f32 v82, v82, v16
    v_mul_f32 v83, v83, v16
    v_mul_f32 v84, v84, v16
    v_mul_f32 v85, v85, v16
    v_mul_f32 v86, v86, v16
    v_mul_f32 v87, v87, v16
    v_cvt_pk_bf16_f32 v120, v24, v25
    v_cvt_pk_bf16_f32 v121, v26, v27
    v_cvt_pk_bf16_f32 v122, v32, v33
    v_cvt_pk_bf16_f32 v123, v34, v35
    buffer_store_dwordx4 v[120:123], v23, s[24:27], 0 offen offset:0 sc1
    v_cvt_pk_bf16_f32 v124, v28, v29
    v_cvt_pk_bf16_f32 v125, v30, v31
    v_cvt_pk_bf16_f32 v126, v36, v37
    v_cvt_pk_bf16_f32 v127, v38, v39
    buffer_store_dwordx4 v[124:127], v23, s[24:27], 0 offen offset:512 sc1
    v_cvt_pk_bf16_f32 v128, v40, v41
    v_cvt_pk_bf16_f32 v129, v42, v43
    v_cvt_pk_bf16_f32 v130, v48, v49
    v_cvt_pk_bf16_f32 v131, v50, v51
    buffer_store_dwordx4 v[128:131], v23, s[24:27], 0 offen offset:1024 sc1
    v_cvt_pk_bf16_f32 v132, v44, v45
    v_cvt_pk_bf16_f32 v133, v46, v47
    v_cvt_pk_bf16_f32 v134, v52, v53
    v_cvt_pk_bf16_f32 v135, v54, v55
    buffer_store_dwordx4 v[132:135], v23, s[24:27], 0 offen offset:1536 sc1
    v_cvt_pk_bf16_f32 v136, v56, v57
    v_cvt_pk_bf16_f32 v137, v58, v59
    v_cvt_pk_bf16_f32 v138, v64, v65
    v_cvt_pk_bf16_f32 v139, v66, v67
    buffer_store_dwordx4 v[136:139], v23, s[24:27], 0 offen offset:2048 sc1
    v_cvt_pk_bf16_f32 v140, v60, v61
    v_cvt_pk_bf16_f32 v141, v62, v63
    v_cvt_pk_bf16_f32 v142, v68, v69
    v_cvt_pk_bf16_f32 v143, v70, v71
    buffer_store_dwordx4 v[140:143], v23, s[24:27], 0 offen offset:2560 sc1
    v_cvt_pk_bf16_f32 v144, v72, v73
    v_cvt_pk_bf16_f32 v145, v74, v75
    v_cvt_pk_bf16_f32 v146, v80, v81
    v_cvt_pk_bf16_f32 v147, v82, v83
    buffer_store_dwordx4 v[144:147], v23, s[24:27], 0 offen offset:3072 sc1
    v_cvt_pk_bf16_f32 v148, v76, v77
    v_cvt_pk_bf16_f32 v149, v78, v79
    v_cvt_pk_bf16_f32 v150, v84, v85
    v_cvt_pk_bf16_f32 v151, v86, v87
    buffer_store_dwordx4 v[148:151], v23, s[24:27], 0 offen offset:3584 sc1
    s_waitcnt vmcnt(0)
L_attn_end:
    s_endpgm
L_rs_0:
    v_mul_f32 v16, v16, v17
    v_mul_f32 v24, v24, v17
    v_mul_f32 v25, v25, v17
    v_mul_f32 v26, v26, v17
    v_mul_f32 v27, v27, v17
    v_mul_f32 v28, v28, v17
    v_mul_f32 v29, v29, v17
    v_mul_f32 v30, v30, v17
    v_mul_f32 v31, v31, v17
    v_mul_f32 v32, v32, v17
    v_mul_f32 v33, v33, v17
    v_mul_f32 v34, v34, v17
    v_mul_f32 v35, v35, v17
    v_mul_f32 v36, v36, v17
    v_mul_f32 v37, v37, v17
    v_mul_f32 v38, v38, v17
    v_mul_f32 v39, v39, v17
    v_mul_f32 v40, v40, v17
    v_mul_f32 v41, v41, v17
    v_mul_f32 v42, v42, v17
    v_mul_f32 v43, v43, v17
    v_mul_f32 v44, v44, v17
    v_mul_f32 v45, v45, v17
    v_mul_f32 v46, v46, v17
    v_mul_f32 v47, v47, v17
    v_mul_f32 v48, v48, v17
    v_mul_f32 v49, v49, v17
    v_mul_f32 v50, v50, v17
    v_mul_f32 v51, v51, v17
    v_mul_f32 v52, v52, v17
    v_mul_f32 v53, v53, v17
    v_mul_f32 v54, v54, v17
    v_mul_f32 v55, v55, v17
    v_mul_f32 v56, v56, v17
    v_mul_f32 v57, v57, v17
    v_mul_f32 v58, v58, v17
    v_mul_f32 v59, v59, v17
    v_mul_f32 v60, v60, v17
    v_mul_f32 v61, v61, v17
    v_mul_f32 v62, v62, v17
    v_mul_f32 v63, v63, v17
    v_mul_f32 v64, v64, v17
    v_mul_f32 v65, v65, v17
    v_mul_f32 v66, v66, v17
    v_mul_f32 v67, v67, v17
    v_mul_f32 v68, v68, v17
    v_mul_f32 v69, v69, v17
    v_mul_f32 v70, v70, v17
    v_mul_f32 v71, v71, v17
    v_mul_f32 v72, v72, v17
    v_mul_f32 v73, v73, v17
    v_mul_f32 v74, v74, v17
    v_mul_f32 v75, v75, v17
    v_mul_f32 v76, v76, v17
    v_mul_f32 v77, v77, v17
    v_mul_f32 v78, v78, v17
    v_mul_f32 v79, v79, v17
    v_mul_f32 v80, v80, v17
    v_mul_f32 v81, v81, v17
    v_mul_f32 v82, v82, v17
    v_mul_f32 v83, v83, v17
    v_mul_f32 v84, v84, v17
    v_mul_f32 v85, v85, v17
    v_mul_f32 v86, v86, v17
    v_mul_f32 v87, v87, v17
    s_mov_b32 s95, 0
    s_branch L_rsback_0
L_slow_0:
    v_max_f32 v19, 0, v19
    v_sub_f32 v17, 0, v19
    v_exp_f32 v17, v17
    v_sub_f32 v152, v152, v19
    v_sub_f32 v153, v153, v19
    v_sub_f32 v154, v154, v19
    v_sub_f32 v155, v155, v19
    v_sub_f32 v156, v156, v19
    v_sub_f32 v157, v157, v19
    v_sub_f32 v158, v158, v19
    v_sub_f32 v159, v159, v19
    v_sub_f32 v160, v160, v19
    v_sub_f32 v161, v161, v19
    v_sub_f32 v162, v162, v19
    v_sub_f32 v163, v163, v19
    v_sub_f32 v164, v164, v19
    v_sub_f32 v165, v165, v19
    v_sub_f32 v166, v166, v19
    v_sub_f32 v167, v167, v19
    v_sub_f32 v168, v168, v19
    v_sub_f32 v169, v169, v19
    v_sub_f32 v170, v170, v19
    v_sub_f32 v171, v171, v19
    v_sub_f32 v172, v172, v19
    v_sub_f32 v173, v173, v19
    v_sub_f32 v174, v174, v19
    v_sub_f32 v175, v175, v19
    v_sub_f32 v176, v176, v19
    v_sub_f32 v177, v177, v19
    v_sub_f32 v178, v178, v19
    v_sub_f32 v179, v179, v19
    v_sub_f32 v180, v180, v19
    v_sub_f32 v181, v181, v19
    v_sub_f32 v182, v182, v19
    v_sub_f32 v183, v183, v19
    v_sub_f32 v240, v240, v19
    v_sub_f32 v241, v241, v19
    v_sub_f32 v242, v242, v19
    v_sub_f32 v243, v243, v19
    v_sub_f32 v244, v244, v19
    v_sub_f32 v245, v245, v19
    v_sub_f32 v246, v246, v19
    v_sub_f32 v247, v247, v19
    v_sub_f32 v248, v248, v19
    v_sub_f32 v249, v249, v19
    v_sub_f32 v250, v250, v19
    v_sub_f32 v251, v251, v19
    v_sub_f32 v252, v252, v19
    v_sub_f32 v253, v253, v19
    v_sub_f32 v254, v254, v19
    v_sub_f32 v255, v255, v19
    s_mov_b32 s95, 1
    s_branch L_back_0
L_rs_1:
    v_mul_f32 v16, v16, v17
    v_mul_f32 v24, v24, v17
    v_mul_f32 v25, v25, v17
    v_mul_f32 v26, v26, v17
    v_mul_f32 v27, v27, v17
    v_mul_f32 v28, v28, v17
    v_mul_f32 v29, v29, v17
    v_mul_f32 v30, v30, v17
    v_mul_f32 v31, v31, v17
    v_mul_f32 v32, v32, v17
    v_mul_f32 v33, v33, v17
    v_mul_f32 v34, v34, v17
    v_mul_f32 v35, v35, v17
    v_mul_f32 v36, v36, v17
    v_mul_f32 v37, v37, v17
    v_mul_f32 v38, v38, v17
    v_mul_f32 v39, v39, v17
    v_mul_f32 v40, v40, v17
    v_mul_f32 v41, v41, v17
    v_mul_f32 v42, v42, v17
    v_mul_f32 v43, v43, v17
    v_mul_f32 v44, v44, v17
    v_mul_f32 v45, v45, v17
    v_mul_f32 v46, v46, v17
    v_mul_f32 v47, v47, v17
    v_mul_f32 v48, v48, v17
    v_mul_f32 v49, v49, v17
    v_mul_f32 v50, v50, v17
    v_mul_f32 v51, v51, v17
    v_mul_f32 v52, v52, v17
    v_mul_f32 v53, v53, v17
    v_mul_f32 v54, v54, v17
    v_mul_f32 v55, v55, v17
    v_mul_f32 v56, v56, v17
    v_mul_f32 v57, v57, v17
    v_mul_f32 v58, v58, v17
    v_mul_f32 v59, v59, v17
    v_mul_f32 v60, v60, v17
    v_mul_f32 v61, v61, v17
    v_mul_f32 v62, v62, v17
    v_mul_f32 v63, v63, v17
    v_mul_f32 v64, v64, v17
    v_mul_f32 v65, v65, v17
    v_mul_f32 v66, v66, v17
    v_mul_f32 v67, v67, v17
    v_mul_f32 v68, v68, v17
    v_mul_f32 v69, v69, v17
    v_mul_f32 v70, v70, v17
    v_mul_f32 v71, v71, v17
    v_mul_f32 v72, v72, v17
    v_mul_f32 v73, v73, v17
    v_mul_f32 v74, v74, v17
    v_mul_f32 v75, v75, v17
    v_mul_f32 v76, v76, v17
    v_mul_f32 v77, v77, v17
    v_mul_f32 v78, v78, v17
    v_mul_f32 v79, v79, v17
    v_mul_f32 v80, v80, v17
    v_mul_f32 v81, v81, v17
    v_mul_f32 v82, v82, v17
    v_mul_f32 v83, v83, v17
    v_mul_f32 v84, v84, v17
    v_mul_f32 v85, v85, v17
    v_mul_f32 v86, v86, v17
    v_mul_f32 v87, v87, v17
    s_mov_b32 s95, 0
    s_branch L_rsback_1
L_slow_1:
    v_max_f32 v19, 0, v19
    v_sub_f32 v17, 0, v19
    v_exp_f32 v17, v17
    v_sub_f32 v120, v120, v19
    v_sub_f32 v121, v121, v19
    v_sub_f32 v122, v122, v19
    v_sub_f32 v123, v123, v19
    v_sub_f32 v124, v124, v19
    v_sub_f32 v125, v125, v19
    v_sub_f32 v126, v126, v19
    v_sub_f32 v127, v127, v19
    v_sub_f32 v128, v128, v19
    v_sub_f32 v129, v129, v19
    v_sub_f32 v130, v130, v19
    v_sub_f32 v131, v131, v19
    v_sub_f32 v132, v132, v19
    v_sub_f32 v133, v133, v19
    v_sub_f32 v134, v134, v19
    v_sub_f32 v135, v135, v19
    v_sub_f32 v136, v136, v19
    v_sub_f32 v137, v137, v19
    v_sub_f32 v138, v138, v19
    v_sub_f32 v139, v139, v19
    v_sub_f32 v140, v140, v19
    v_sub_f32 v141, v141, v19
    v_sub_f32 v142, v142, v19
    v_sub_f32 v143, v143, v19
    v_sub_f32 v144, v144, v19
    v_sub_f32 v145, v145, v19
    v_sub_f32 v146, v146, v19
    v_sub_f32 v147, v147, v19
    v_sub_f32 v148, v148, v19
    v_sub_f32 v149, v149, v19
    v_sub_f32 v150, v150, v19
    v_sub_f32 v151, v151, v19
    v_sub_f32 v240, v240, v19
    v_sub_f32 v241, v241, v19
    v_sub_f32 v242, v242, v19
    v_sub_f32 v243, v243, v19
    v_sub_f32 v244, v244, v19
    v_sub_f32 v245, v245, v19
    v_sub_f32 v246, v246, v19
    v_sub_f32 v247, v247, v19
    v_sub_f32 v248, v248, v19
    v_sub_f32 v249, v249, v19
    v_sub_f32 v250, v250, v19
    v_sub_f32 v251, v251, v19
    v_sub_f32 v252, v252, v19
    v_sub_f32 v253, v253, v19
    v_sub_f32 v254, v254, v19
    v_sub_f32 v255, v255, v19
    s_mov_b32 s95, 1
    s_branch L_back_1
.globl oproj_kernel
.p2align 8
.type oproj_kernel,@function
oproj_kernel:
    s_cmp_ge_u32 s2, 256
    s_cbranch_scc1 L_op_end
    s_and_b32 s29, s2, 3
    s_bfe_u32 s28, s2, 0x10002
    s_bfe_u32 s31, s2, 0x20003
    s_lshr_b32 s30, s2, 5
    s_mul_i32 s3, s28, 40
    s_add_u32 s4, s0, s3
    s_addc_u32 s5, s1, 0
    s_load_dwordx2 s[34:35], s[4:5], 32
    s_load_dwordx2 s[38:39], s[0:1], 80
    s_load_dwordx2 s[40:41], s[0:1], 88
    s_load_dwordx2 s[36:37], s[0:1], 96
    v_and_b32 v1, 63, v0
    v_lshrrev_b32 v2, 6, v0
    s_nop 0
    v_readfirstlane_b32 s32, v2
    v_lshl_add_u32 v2, v2, 6, v1
    v_add_u32 v3, 0, v2
    v_mul_u32_u24 v4, 3641, v3
    v_lshrrev_b32 v4, 16, v4
    v_mul_u32_u24 v5, 18, v4
    v_sub_u32 v5, v3, v5
    v_mul_u32_u24 v4, 1152, v4
    v_lshl_add_u32 v6, v5, 4, v4
    v_add_u32 v3, 256, v2
    v_mul_u32_u24 v4, 3641, v3
    v_lshrrev_b32 v4, 16, v4
    v_mul_u32_u24 v5, 18, v4
    v_sub_u32 v5, v3, v5
    v_mul_u32_u24 v4, 1152, v4
    v_lshl_add_u32 v7, v5, 4, v4
    v_add_u32 v3, 512, v2
    v_mul_u32_u24 v4, 3641, v3
    v_lshrrev_b32 v4, 16, v4
    v_mul_u32_u24 v5, 18, v4
    v_sub_u32 v5, v3, v5
    v_mul_u32_u24 v4, 1152, v4
    v_lshl_add_u32 v8, v5, 4, v4
    v_cmp_gt_u32 vcc, 576, v3
    v_mov_b32 v4, 0x7ffffff0
    s_nop 1
    v_cndmask_b32 v8, v4, v8, vcc
    v_lshrrev_b32 v2, 2, v1
    v_mul_u32_u24 v2, 288, v2
    v_and_b32 v3, 3, v1
    v_lshl_add_u32 v17, v3, 3, v2
    s_lshl_b32 s3, s32, 18
    s_lshl_b32 s4, s29, 15
    s_add_u32 s3, s3, s4
    v_lshlrev_b32 v2, 4, v1
    v_add_u32 v15, s3, v2
    v_add_u32 v16, 0x20000, v15
    s_waitcnt lgkmcnt(0)
    s_mul_i32 s3, s29, 1179648
    s_mul_i32 s4, s31, 288
    s_add_u32 s3, s3, s4
    s_add_u32 s8, s34, s3
    s_addc_u32 s9, s35, 0
    s_sub_u32 s10, 4718592, s3
    s_mov_b32 s11, 0x20000
    s_lshl_b32 s3, s28, 3
    s_add_u32 s3, s3, s30
    s_lshl_b32 s46, s3, 2
    s_add_u32 s46, s46, s31
    s_lshl_b32 s3, s3, 20
    s_add_u32 s12, s36, s3
    s_addc_u32 s13, s37, 0
    s_mov_b32 s14, 1048576
    s_mov_b32 s15, 0x20000
    s_mul_i32 s3, s46, 294912
    s_add_u32 s3, s3, 16777216
    s_add_u32 s16, s36, s3
    s_addc_u32 s17, s37, 0
    s_mov_b32 s18, 294912
    s_mov_b32 s19, 0x20000
    s_mov_b32 s20, s40
    s_mov_b32 s21, s41
    s_mov_b32 s22, 256
    s_mov_b32 s23, 0x20000
    s_lshl_b32 s3, s30, 7
    s_lshl_b32 s4, s32, 5
    s_add_u32 s3, s3, s4
    s_mul_i32 s3, s3, 2304
    s_mul_i32 s4, s28, 1152
    s_add_u32 s3, s3, s4
    s_mul_i32 s4, s31, 288
    s_add_u32 s3, s3, s4
    s_add_u32 s24, s38, s3
    s_addc_u32 s25, s39, 0
    s_sub_u32 s26, 2359296, s3
    s_mov_b32 s27, 0x20000
    s_lshl_b32 s42, s32, 10
    s_cmp_eq_u32 s32, 0
    s_movk_i32 s50, 9216
    s_cselect_b32 s50, 8192, s50
    s_mov_b32 s48, 0
    s_add_u32 s4, s36, 58720256
    s_addc_u32 s5, s37, 0
    s_load_dword s47, s[4:5], 0
    s_waitcnt lgkmcnt(0)
    s_add_u32 s49, s48, 0
    s_and_b32 s49, s49, 7
    s_mul_i32 s43, s49, 147456
    s_lshl_b32 s44, s49, 12
    s_add_u32 m0, s42, 0
    s_nop 0
    buffer_load_dwordx4 v6, s[8:11], s43 offen lds
    s_add_u32 m0, s42, 4096
    s_nop 0
    buffer_load_dwordx4 v7, s[8:11], s43 offen lds
    s_add_u32 m0, s50, 0
    s_nop 0
    buffer_load_dwordx4 v8, s[8:11], s43 offen lds
    buffer_load_dwordx4 v[128:131], v15, s[12:15], s44 offen offset:0
    buffer_load_dwordx4 v[132:135], v16, s[12:15], s44 offen offset:0
    s_add_u32 s43, s43, 36864
    s_add_u32 m0, s42, 10240
    s_nop 0
    buffer_load_dwordx4 v6, s[8:11], s43 offen lds
    s_add_u32 m0, s42, 14336
    s_nop 0
    buffer_load_dwordx4 v7, s[8:11], s43 offen lds
    s_add_u32 m0, s50, 10240
    s_nop 0
    buffer_load_dwordx4 v8, s[8:11], s43 offen lds
    buffer_load_dwordx4 v[136:139], v15, s[12:15], s44 offen offset:1024
    buffer_load_dwordx4 v[140:143], v16, s[12:15], s44 offen offset:1024
    s_add_u32 s43, s43, 36864
    s_add_u32 m0, s42, 20480
    s_nop 0
    buffer_load_dwordx4 v6, s[8:11], s43 offen lds
    s_add_u32 m0, s42, 24576
    s_nop 0
    buffer_load_dwordx4 v7, s[8:11], s43 offen lds
    s_add_u32 m0, s50, 20480
    s_nop 0
    buffer_load_dwordx4 v8, s[8:11], s43 offen lds
    buffer_load_dwordx4 v[144:147], v15, s[12:15], s44 offen offset:2048
    buffer_load_dwordx4 v[148:151], v16, s[12:15], s44 offen offset:2048
    s_add_u32 s43, s43, 36864
    s_add_u32 m0, s42, 30720
    s_nop 0
    buffer_load_dwordx4 v6, s[8:11], s43 offen lds
    s_add_u32 m0, s42, 34816
    s_nop 0
    buffer_load_dwordx4 v7, s[8:11], s43 offen lds
    s_add_u32 m0, s50, 30720
    s_nop 0
    buffer_load_dwordx4 v8, s[8:11], s43 offen lds
    buffer_load_dwordx4 v[152:155], v15, s[12:15], s44 offen offset:3072
    buffer_load_dwordx4 v[156:159], v16, s[12:15], s44 offen offset:3072
    s_add_u32 s49, s48, 1
    s_and_b32 s49, s49, 7
    s_mul_i32 s43, s49, 147456
    s_lshl_b32 s44, s49, 12
    s_add_u32 m0, s42, 40960
    s_nop 0
    buffer_load_dwordx4 v6, s[8:11], s43 offen lds
    s_add_u32 m0, s42, 45056
    s_nop 0
    buffer_load_dwordx4 v7, s[8:11], s43 offen lds
    s_add_u32 m0, s50, 40960
    s_nop 0
    buffer_load_dwordx4 v8, s[8:11], s43 offen lds
    buffer_load_dwordx4 v[160:163], v15, s[12:15], s44 offen offset:0
    buffer_load_dwordx4 v[164:167], v16, s[12:15], s44 offen offset:0
    s_add_u32 s43, s43, 36864
    s_add_u32 m0, s42, 51200
    s_nop 0
    buffer_load_dwordx4 v6, s[8:11], s43 offen lds
    s_add_u32 m0, s42, 55296
    s_nop 0
    buffer_load_dwordx4 v7, s[8:11], s43 offen lds
    s_add_u32 m0, s50, 51200
    s_nop 0
    buffer_load_dwordx4 v8, s[8:11], s43 offen lds
    buffer_load_dwordx4 v[168:171], v15, s[12:15], s44 offen offset:1024
    buffer_load_dwordx4 v[172:175], v16, s[12:15], s44 offen offset:1024
    s_add_u32 s43, s43, 36864
    s_add_u32 m0, s42, 61440
    s_nop 0
    buffer_load_dwordx4 v6, s[8:11], s43 offen lds
    s_add_u32 m0, s42, 65536
    s_nop 0
    buffer_load_dwordx4 v7, s[8:11], s43 offen lds
    s_add_u32 m0, s50, 61440
    s_nop 0
    buffer_load_dwordx4 v8, s[8:11], s43 offen lds
    buffer_load_dwordx4 v[176:179], v15, s[12:15], s44 offen offset:2048
    buffer_load_dwordx4 v[180:183], v16, s[12:15], s44 offen offset:2048
    s_add_u32 s43, s43, 36864
    s_add_u32 m0, s42, 71680
    s_nop 0
    buffer_load_dwordx4 v6, s[8:11], s43 offen lds
    s_add_u32 m0, s42, 75776
    s_nop 0
    buffer_load_dwordx4 v7, s[8:11], s43 offen lds
    s_add_u32 m0, s50, 71680
    s_nop 0
    buffer_load_dwordx4 v8, s[8:11], s43 offen lds
    buffer_load_dwordx4 v[184:187], v15, s[12:15], s44 offen offset:3072
    buffer_load_dwordx4 v[188:191], v16, s[12:15], s44 offen offset:3072
    s_add_u32 s49, s48, 2
    s_and_b32 s49, s49, 7
    s_mul_i32 s43, s49, 147456
    s_lshl_b32 s44, s49, 12
    s_add_u32 m0, s42, 81920
    s_nop 0
    buffer_load_dwordx4 v6, s[8:11], s43 offen lds
    s_add_u32 m0, s42, 86016
    s_nop 0
    buffer_load_dwordx4 v7, s[8:11], s43 offen lds
    s_add_u32 m0, s50, 81920
    s_nop 0
    buffer_load_dwordx4 v8, s[8:11], s43 offen lds
    buffer_load_dwordx4 v[192:195], v15, s[12:15], s44 offen offset:0
    buffer_load_dwordx4 v[196:199], v16, s[12:15], s44 offen offset:0
    s_add_u32 s43, s43, 36864
    s_add_u32 m0, s42, 92160
    s_nop 0
    buffer_load_dwordx4 v6, s[8:11], s43 offen lds
    s_add_u32 m0, s42, 96256
    s_nop 0
    buffer_load_dwordx4 v7, s[8:11], s43 offen lds
    s_add_u32 m0, s50, 92160
    s_nop 0
    buffer_load_dwordx4 v8, s[8:11], s43 offen lds
    buffer_load_dwordx4 v[200:203], v15, s[12:15], s44 offen offset:1024
    buffer_load_dwordx4 v[204:207], v16, s[12:15], s44 offen offset:1024
    s_add_u32 s43, s43, 36864
    s_add_u32 m0, s42, 102400
    s_nop 0
    buffer_load_dwordx4 v6, s[8:11], s43 offen lds
    s_add_u32 m0, s42, 106496
    s_nop 0
    buffer_load_dwordx4 v7, s[8:11], s43 offen lds
    s_add_u32 m0, s50, 102400
    s_nop 0
    buffer_load_dwordx4 v8, s[8:11], s43 offen lds
    buffer_load_dwordx4 v[208:211], v15, s[12:15], s44 offen offset:2048
    buffer_load_dwordx4 v[212:215], v16, s[12:15], s44 offen offset:2048
    s_add_u32 s43, s43, 36864
    s_add_u32 m0, s42, 112640
    s_nop 0
    buffer_load_dwordx4 v6, s[8:11], s43 offen lds
    s_add_u32 m0, s42, 116736
    s_nop 0
    buffer_load_dwordx4 v7, s[8:11], s43 offen lds
    s_add_u32 m0, s50, 112640
    s_nop 0
    buffer_load_dwordx4 v8, s[8:11], s43 offen lds
    buffer_load_dwordx4 v[216:219], v15, s[12:15], s44 offen offset:3072
    buffer_load_dwordx4 v[220:223], v16, s[12:15], s44 offen offset:3072
    s_waitcnt vmcnt(55)
    s_barrier
    v_add_u32 v18, 0, v17
    ds_read_b64_tr_b16 v[96:97], v18 offset:0
    ds_read_b64_tr_b16 v[98:99], v18 offset:4608
    ds_read_b64_tr_b16 v[100:101], v18 offset:32
    ds_read_b64_tr_b16 v[102:103], v18 offset:4640
    ds_read_b64_tr_b16 v[104:105], v18 offset:64
    ds_read_b64_tr_b16 v[106:107], v18 offset:4672
    ds_read_b64_tr_b16 v[108:109], v18 offset:96
    ds_read_b64_tr_b16 v[110:111], v18 offset:4704
    ds_read_b64_tr_b16 v[112:113], v18 offset:128
    ds_read_b64_tr_b16 v[114:115], v18 offset:4736
    ds_read_b64_tr_b16 v[116:117], v18 offset:160
    ds_read_b64_tr_b16 v[118:119], v18 offset:4768
    ds_read_b64_tr_b16 v[120:121], v18 offset:192
    ds_read_b64_tr_b16 v[122:123], v18 offset:4800
    s_waitcnt lgkmcnt(12)
    v_mfma_f32_16x16x32_bf16 v[24:27], v[96:99], v[128:131], 0
    ds_read_b64_tr_b16 v[124:125], v18 offset:224
    v_mfma_f32_16x16x32_bf16 v[28:31], v[96:99], v[132:135], 0
    ds_read_b64_tr_b16 v[126:127], v18 offset:4832
    s_add_u32 s49, s48, 3
    s_and_b32 s49, s49, 7
    s_mul_i32 s43, s49, 147456
    s_lshl_b32 s44, s49, 12
    s_add_u32 m0, s42, 122880
    s_nop 0
    buffer_load_dwordx4 v6, s[8:11], s43 offen lds
    s_waitcnt lgkmcnt(12)
    v_mfma_f32_16x16x32_bf16 v[32:35], v[100:103], v[128:131], 0
    ds_read_b64_tr_b16 v[96:97], v18 offset:256
    v_mfma_f32_16x16x32_bf16 v[36:39], v[100:103], v[132:135], 0
    ds_read_b64_tr_b16 v[98:99], v18 offset:4864
    s_add_u32 m0, s42, 126976
    s_nop 0
    buffer_load_dwordx4 v7, s[8:11], s43 offen lds
    s_waitcnt lgkmcnt(12)
    v_mfma_f32_16x16x32_bf16 v[40:43], v[104:107], v[128:131], 0
    v_mfma_f32_16x16x32_bf16 v[44:47], v[104:107], v[132:135], 0
    s_add_u32 m0, s50, 122880
    s_nop 0
    buffer_load_dwordx4 v8, s[8:11], s43 offen lds
    s_waitcnt lgkmcnt(10)
    v_mfma_f32_16x16x32_bf16 v[48:51], v[108:111], v[128:131], 0
    v_mfma_f32_16x16x32_bf16 v[52:55], v[108:111], v[132:135], 0
    buffer_load_dwordx4 v[224:227], v15, s[12:15], s44 offen offset:0
    s_waitcnt lgkmcnt(8)
    v_mfma_f32_16x16x32_bf16 v[56:59], v[112:115], v[128:131], 0
    v_mfma_f32_16x16x32_bf16 v[60:63], v[112:115], v[132:135], 0
    buffer_load_dwordx4 v[228:231], v16, s[12:15], s44 offen offset:0
    s_waitcnt lgkmcnt(6)
    v_mfma_f32_16x16x32_bf16 v[64:67], v[116:119], v[128:131], 0
    v_mfma_f32_16x16x32_bf16 v[68:71], v[116:119], v[132:135], 0
    s_add_u32 s43, s43, 36864
    s_add_u32 m0, s42, 133120
    s_nop 0
    buffer_load_dwordx4 v6, s[8:11], s43 offen lds
    s_waitcnt lgkmcnt(4)
    v_mfma_f32_16x16x32_bf16 v[72:75], v[120:123], v[128:131], 0
    v_mfma_f32_16x16x32_bf16 v[76:79], v[120:123], v[132:135], 0
    s_add_u32 m0, s42, 137216
    s_nop 0
    buffer_load_dwordx4 v7, s[8:11], s43 offen lds
    s_waitcnt lgkmcnt(2)
    v_mfma_f32_16x16x32_bf16 v[80:83], v[124:127], v[128:131], 0
    v_mfma_f32_16x16x32_bf16 v[84:87], v[124:127], v[132:135], 0
    s_add_u32 m0, s50, 133120
    s_nop 0
    buffer_load_dwordx4 v8, s[8:11], s43 offen lds
    s_waitcnt lgkmcnt(0)
    v_mfma_f32_16x16x32_bf16 v[88:91], v[96:99], v[128:131], 0
    v_mfma_f32_16x16x32_bf16 v[92:95], v[96:99], v[132:135], 0
    buffer_load_dwordx4 v[232:235], v15, s[12:15], s44 offen offset:1024
    s_waitcnt vmcnt(59)
    s_barrier
    ds_read_b64_tr_b16 v[100:101], v18 offset:10240
    ds_read_b64_tr_b16 v[102:103], v18 offset:14848
    ds_read_b64_tr_b16 v[104:105], v18 offset:10272
    ds_read_b64_tr_b16 v[106:107], v18 offset:14880
    ds_read_b64_tr_b16 v[108:109], v18 offset:10304
    ds_read_b64_tr_b16 v[110:111], v18 offset:14912
    ds_read_b64_tr_b16 v[112:113], v18 offset:10336
    ds_read_b64_tr_b16 v[114:115], v18 offset:14944
    ds_read_b64_tr_b16 v[116:117], v18 offset:10368
    ds_read_b64_tr_b16 v[118:119], v18 offset:14976
    ds_read_b64_tr_b16 v[120:121], v18 offset:10400
    ds_read_b64_tr_b16 v[122:123], v18 offset:15008
    ds_read_b64_tr_b16 v[124:125], v18 offset:10432
    ds_read_b64_tr_b16 v[126:127], v18 offset:15040
    s_waitcnt lgkmcnt(12)
    v_mfma_f32_16x16x32_bf16 v[24:27], v[100:103], v[136:139], v[24:27]
    ds_read_b64_tr_b16 v[96:97], v18 offset:10464
    v_mfma_f32_16x16x32_bf16 v[28:31], v[100:103], v[140:143], v[28:31]
    ds_read_b64_tr_b16 v[98:99], v18 offset:15072
    buffer_load_dwordx4 v[236:239], v16, s[12:15], s44 offen offset:1024
    s_waitcnt lgkmcnt(12)
    v_mfma_f32_16x16x32_bf16 v[32:35], v[104:107], v[136:139], v[32:35]
    ds_read_b64_tr_b16 v[100:101], v18 offset:10496
    v_mfma_f32_16x16x32_bf16 v[36:39], v[104:107], v[140:143], v[36:39]
    ds_read_b64_tr_b16 v[102:103], v18 offset:15104
    s_add_u32 s43, s43, 36864
    s_add_u32 m0, s42, 143360
    s_nop 0
    buffer_load_dwordx4 v6, s[8:11], s43 offen lds
    s_waitcnt lgkmcnt(12)
    v_mfma_f32_16x16x32_bf16 v[40:43], v[108:111], v[136:139], v[40:43]
    v_mfma_f32_16x16x32_bf16 v[44:47], v[108:111], v[140:143], v[44:47]
    s_add_u32 m0, s42, 147456
    s_nop 0
    buffer_load_dwordx4 v7, s[8:11], s43 offen lds
    s_waitcnt lgkmcnt(10)
    v_mfma_f32_16x16x32_bf16 v[48:51], v[112:115], v[136:139], v[48:51]
    v_mfma_f32_16x16x32_bf16 v[52:55], v[112:115], v[140:143], v[52:55]
    s_add_u32 m0, s50, 143360
    s_nop 0
    buffer_load_dwordx4 v8, s[8:11], s43 offen lds
    s_waitcnt lgkmcnt(8)
    v_mfma_f32_16x16x32_bf16 v[56:59], v[116:119], v[136:139], v[56:59]
    v_mfma_f32_16x16x32_bf16 v[60:63], v[116:119], v[140:143], v[60:63]
    buffer_load_dwordx4 v[240:243], v15, s[12:15], s44 offen offset:2048
    s_waitcnt lgkmcnt(6)
    v_mfma_f32_16x16x32_bf16 v[64:67], v[120:123], v[136:139], v[64:67]
    v_mfma_f32_16x16x32_bf16 v[68:71], v[120:123], v[140:143], v[68:71]
    buffer_load_dwordx4 v[244:247], v16, s[12:15], s44 offen offset:2048
    s_waitcnt lgkmcnt(4)
    v_mfma_f32_16x16x32_bf16 v[72:75], v[124:127], v[136:139], v[72:75]
    v_mfma_f32_16x16x32_bf16 v[76:79], v[124:127], v[140:143], v[76:79]
    s_add_u32 s43, s43, 36864
    s_add_u32 m0, s42, 153600
    s_nop 0
    buffer_load_dwordx4 v6, s[8:11], s43 offen lds
    s_waitcnt lgkmcnt(2)
    v_mfma_f32_16x16x32_bf16 v[80:83], v[96:99], v[136:139], v[80:83]
    v_mfma_f32_16x16x32_bf16 v[84:87], v[96:99], v[140:143], v[84:87]
    s_add_u32 m0, s42, 157696
    s_nop 0
    buffer_load_dwordx4 v7, s[8:11], s43 offen lds
    s_waitcnt lgkmcnt(0)
    v_mfma_f32_16x16x32_bf16 v[88:91], v[100:103], v[136:139], v[88:91]
    v_mfma_f32_16x16x32_bf16 v[92:95], v[100:103], v[140:143], v[92:95]
    s_add_u32 m0, s50, 153600
    s_nop 0
    buffer_load_dwordx4 v8, s[8:11], s43 offen lds
    s_waitcnt vmcnt(63)
    s_barrier
    ds_read_b64_tr_b16 v[104:105], v18 offset:20480
    ds_read_b64_tr_b16 v[106:107], v18 offset:25088
    ds_read_b64_tr_b16 v[108:109], v18 offset:20512
    ds_read_b64_tr_b16 v[110:111], v18 offset:25120
    ds_read_b64_tr_b16 v[112:113], v18 offset:20544
    ds_read_b64_tr_b16 v[114:115], v18 offset:25152
    ds_read_b64_tr_b16 v[116:117], v18 offset:20576
    ds_read_b64_tr_b16 v[118:119], v18 offset:25184
    ds_read_b64_tr_b16 v[120:121], v18 offset:20608
    ds_read_b64_tr_b16 v[122:123], v18 offset:25216
    ds_read_b64_tr_b16 v[124:125], v18 offset:20640
    ds_read_b64_tr_b16 v[126:127], v18 offset:25248
    ds_read_b64_tr_b16 v[96:97], v18 offset:20672
    ds_read_b64_tr_b16 v[98:99], v18 offset:25280
    s_waitcnt lgkmcnt(12)
    v_mfma_f32_16x16x32_bf16 v[24:27], v[104:107], v[144:147], v[24:27]
    ds_read_b64_tr_b16 v[100:101], v18 offset:20704
    v_mfma_f32_16x16x32_bf16 v[28:31], v[104:107], v[148:151], v[28:31]
    ds_read_b64_tr_b16 v[102:103], v18 offset:25312
    buffer_load_dwordx4 v[248:251], v15, s[12:15], s44 offen offset:3072
    s_waitcnt lgkmcnt(12)
    v_mfma_f32_16x16x32_bf16 v[32:35], v[108:111], v[144:147], v[32:35]
    ds_read_b64_tr_b16 v[104:105], v18 offset:20736
    v_mfma_f32_16x16x32_bf16 v[36:39], v[108:111], v[148:151], v[36:39]
    ds_read_b64_tr_b16 v[106:107], v18 offset:25344
    buffer_load_dwordx4 v[252:255], v16, s[12:15], s44 offen offset:3072
    s_waitcnt lgkmcnt(12)
    v_mfma_f32_16x16x32_bf16 v[40:43], v[112:115], v[144:147], v[40:43]
    v_mfma_f32_16x16x32_bf16 v[44:47], v[112:115], v[148:151], v[44:47]
    s_waitcnt lgkmcnt(10)
    v_mfma_f32_16x16x32_bf16 v[48:51], v[116:119], v[144:147], v[48:51]
    v_mfma_f32_16x16x32_bf16 v[52:55], v[116:119], v[148:151], v[52:55]
    s_waitcnt lgkmcnt(8)
    v_mfma_f32_16x16x32_bf16 v[56:59], v[120:123], v[144:147], v[56:59]
    v_mfma_f32_16x16x32_bf16 v[60:63], v[120:123], v[148:151], v[60:63]
    s_waitcnt lgkmcnt(6)
    v_mfma_f32_16x16x32_bf16 v[64:67], v[124:127], v[144:147], v[64:67]
    v_mfma_f32_16x16x32_bf16 v[68:71], v[124:127], v[148:151], v[68:71]
    s_waitcnt lgkmcnt(4)
    v_mfma_f32_16x16x32_bf16 v[72:75], v[96:99], v[144:147], v[72:75]
    v_mfma_f32_16x16x32_bf16 v[76:79], v[96:99], v[148:151], v[76:79]
    s_waitcnt lgkmcnt(2)
    v_mfma_f32_16x16x32_bf16 v[80:83], v[100:103], v[144:147], v[80:83]
    v_mfma_f32_16x16x32_bf16 v[84:87], v[100:103], v[148:151], v[84:87]
    s_waitcnt lgkmcnt(0)
    v_mfma_f32_16x16x32_bf16 v[88:91], v[104:107], v[144:147], v[88:91]
    v_mfma_f32_16x16x32_bf16 v[92:95], v[104:107], v[148:151], v[92:95]
    s_waitcnt vmcnt(60)
    s_barrier
    ds_read_b64_tr_b16 v[108:109], v18 offset:30720
    ds_read_b64_tr_b16 v[110:111], v18 offset:35328
    ds_read_b64_tr_b16 v[112:113], v18 offset:30752
    ds_read_b64_tr_b16 v[114:115], v18 offset:35360
    ds_read_b64_tr_b16 v[116:117], v18 offset:30784
    ds_read_b64_tr_b16 v[118:119], v18 offset:35392
    ds_read_b64_tr_b16 v[120:121], v18 offset:30816
    ds_read_b64_tr_b16 v[122:123], v18 offset:35424
    ds_read_b64_tr_b16 v[124:125], v18 offset:30848
    ds_read_b64_tr_b16 v[126:127], v18 offset:35456
    ds_read_b64_tr_b16 v[96:97], v18 offset:30880
    ds_read_b64_tr_b16 v[98:99], v18 offset:35488
    ds_read_b64_tr_b16 v[100:101], v18 offset:30912
    ds_read_b64_tr_b16 v[102:103], v18 offset:35520
    s_waitcnt lgkmcnt(12)
    v_mfma_f32_16x16x32_bf16 v[24:27], v[108:111], v[152:155], v[24:27]
    ds_read_b64_tr_b16 v[104:105], v18 offset:30944
    v_mfma_f32_16x16x32_bf16 v[28:31], v[108:111], v[156:159], v[28:31]
    ds_read_b64_tr_b16 v[106:107], v18 offset:35552
    s_waitcnt lgkmcnt(12)
    v_mfma_f32_16x16x32_bf16 v[32:35], v[112:115], v[152:155], v[32:35]
    ds_read_b64_tr_b16 v[108:109], v18 offset:30976
    v_mfma_f32_16x16x32_bf16 v[36:39], v[112:115], v[156:159], v[36:39]
    ds_read_b64_tr_b16 v[110:111], v18 offset:35584
    s_waitcnt lgkmcnt(12)
    v_mfma_f32_16x16x32_bf16 v[40:43], v[116:119], v[152:155], v[40:43]
    v_mfma_f32_16x16x32_bf16 v[44:47], v[116:119], v[156:159], v[44:47]
    s_waitcnt lgkmcnt(10)
    v_mfma_f32_16x16x32_bf16 v[48:51], v[120:123], v[152:155], v[48:51]
    v_mfma_f32_16x16x32_bf16 v[52:55], v[120:123], v[156:159], v[52:55]
    s_waitcnt lgkmcnt(8)
    v_mfma_f32_16x16x32_bf16 v[56:59], v[124:127], v[152:155], v[56:59]
    v_mfma_f32_16x16x32_bf16 v[60:63], v[124:127], v[156:159], v[60:63]
    s_waitcnt lgkmcnt(6)
    v_mfma_f32_16x16x32_bf16 v[64:67], v[96:99], v[152:155], v[64:67]
    v_mfma_f32_16x16x32_bf16 v[68:71], v[96:99], v[156:159], v[68:71]
    s_waitcnt lgkmcnt(4)
    v_mfma_f32_16x16x32_bf16 v[72:75], v[100:103], v[152:155], v[72:75]
    v_mfma_f32_16x16x32_bf16 v[76:79], v[100:103], v[156:159], v[76:79]
    s_waitcnt lgkmcnt(2)
    v_mfma_f32_16x16x32_bf16 v[80:83], v[104:107], v[152:155], v[80:83]
    v_mfma_f32_16x16x32_bf16 v[84:87], v[104:107], v[156:159], v[84:87]
    s_waitcnt lgkmcnt(0)
    v_mfma_f32_16x16x32_bf16 v[88:91], v[108:111], v[152:155], v[88:91]
    v_mfma_f32_16x16x32_bf16 v[92:95], v[108:111], v[156:159], v[92:95]
    s_waitcnt vmcnt(55)
    s_barrier
    v_add_u32 v18, 40960, v17
    ds_read_b64_tr_b16 v[96:97], v18 offset:0
    ds_read_b64_tr_b16 v[98:99], v18 offset:4608
    ds_read_b64_tr_b16 v[100:101], v18 offset:32
    ds_read_b64_tr_b16 v[102:103], v18 offset:4640
    ds_read_b64_tr_b16 v[104:105], v18 offset:64
    ds_read_b64_tr_b16 v[106:107], v18 offset:4672
    ds_read_b64_tr_b16 v[108:109], v18 offset:96
    ds_read_b64_tr_b16 v[110:111], v18 offset:4704
    ds_read_b64_tr_b16 v[112:113], v18 offset:128
    ds_read_b64_tr_b16 v[114:115], v18 offset:4736
    ds_read_b64_tr_b16 v[116:117], v18 offset:160
    ds_read_b64_tr_b16 v[118:119], v18 offset:4768
    ds_read_b64_tr_b16 v[120:121], v18 offset:192
    ds_read_b64_tr_b16 v[122:123], v18 offset:4800
    s_waitcnt lgkmcnt(12)
    v_mfma_f32_16x16x32_bf16 v[24:27], v[96:99], v[160:163], v[24:27]
    ds_read_b64_tr_b16 v[124:125], v18 offset:224
    v_mfma_f32_16x16x32_bf16 v[28:31], v[96:99], v[164:167], v[28:31]
    ds_read_b64_tr_b16 v[126:127], v18 offset:4832
    s_add_u32 s49, s48, 4
    s_and_b32 s49, s49, 7
    s_mul_i32 s43, s49, 147456
    s_lshl_b32 s44, s49, 12
    s_add_u32 m0, s42, 0
    s_nop 0
    buffer_load_dwordx4 v6, s[8:11], s43 offen lds
    s_waitcnt lgkmcnt(12)
    v_mfma_f32_16x16x32_bf16 v[32:35], v[100:103], v[160:163], v[32:35]
    ds_read_b64_tr_b16 v[96:97], v18 offset:256
    v_mfma_f32_16x16x32_bf16 v[36:39], v[100:103], v[164:167], v[36:39]
    ds_read_b64_tr_b16 v[98:99], v18 offset:4864
    s_add_u32 m0, s42, 4096
    s_nop 0
    buffer_load_dwordx4 v7, s[8:11], s43 offen lds
    s_waitcnt lgkmcnt(12)
    v_mfma_f32_16x16x32_bf16 v[40:43], v[104:107], v[160:163], v[40:43]
    v_mfma_f32_16x16x32_bf16 v[44:47], v[104:107], v[164:167], v[44:47]
    s_add_u32 m0, s50, 0
    s_nop 0
    buffer_load_dwordx4 v8, s[8:11], s43 offen lds
    s_waitcnt lgkmcnt(10)
    v_mfma_f32_16x16x32_bf16 v[48:51], v[108:111], v[160:163], v[48:51]
    v_mfma_f32_16x16x32_bf16 v[52:55], v[108:111], v[164:167], v[52:55]
    buffer_load_dwordx4 v[128:131], v15, s[12:15], s44 offen offset:0
    s_waitcnt lgkmcnt(8)
    v_mfma_f32_16x16x32_bf16 v[56:59], v[112:115], v[160:163], v[56:59]
    v_mfma_f32_16x16x32_bf16 v[60:63], v[112:115], v[164:167], v[60:63]
    buffer_load_dwordx4 v[132:135], v16, s[12:15], s44 offen offset:0
    s_waitcnt lgkmcnt(6)
    v_mfma_f32_16x16x32_bf16 v[64:67], v[116:119], v[160:163], v[64:67]
    v_mfma_f32_16x16x32_bf16 v[68:71], v[116:119], v[164:167], v[68:71]
    s_add_u32 s43, s43, 36864
    s_add_u32 m0, s42, 10240
    s_nop 0
    buffer_load_dwordx4 v6, s[8:11], s43 offen lds
    s_waitcnt lgkmcnt(4)
    v_mfma_f32_16x16x32_bf16 v[72:75], v[120:123], v[160:163], v[72:75]
    v_mfma_f32_16x16x32_bf16 v[76:79], v[120:123], v[164:167], v[76:79]
    s_add_u32 m0, s42, 14336
    s_nop 0
    buffer_load_dwordx4 v7, s[8:11], s43 offen lds
    s_waitcnt lgkmcnt(2)
    v_mfma_f32_16x16x32_bf16 v[80:83], v[124:127], v[160:163], v[80:83]
    v_mfma_f32_16x16x32_bf16 v[84:87], v[124:127], v[164:167], v[84:87]
    s_add_u32 m0, s50, 10240
    s_nop 0
    buffer_load_dwordx4 v8, s[8:11], s43 offen lds
    s_waitcnt lgkmcnt(0)
    v_mfma_f32_16x16x32_bf16 v[88:91], v[96:99], v[160:163], v[88:91]
    v_mfma_f32_16x16x32_bf16 v[92:95], v[96:99], v[164:167], v[92:95]
    buffer_load_dwordx4 v[136:139], v15, s[12:15], s44 offen offset:1024
    s_waitcnt vmcnt(59)
    s_barrier
    ds_read_b64_tr_b16 v[100:101], v18 offset:10240
    ds_read_b64_tr_b16 v[102:103], v18 offset:14848
    ds_read_b64_tr_b16 v[104:105], v18 offset:10272
    ds_read_b64_tr_b16 v[106:107], v18 offset:14880
    ds_read_b64_tr_b16 v[108:109], v18 offset:10304
    ds_read_b64_tr_b16 v[110:111], v18 offset:14912
    ds_read_b64_tr_b16 v[112:113], v18 offset:10336
    ds_read_b64_tr_b16 v[114:115], v18 offset:14944
    ds_read_b64_tr_b16 v[116:117], v18 offset:10368
    ds_read_b64_tr_b16 v[118:119], v18 offset:14976
    ds_read_b64_tr_b16 v[120:121], v18 offset:10400
    ds_read_b64_tr_b16 v[122:123], v18 offset:15008
    ds_read_b64_tr_b16 v[124:125], v18 offset:10432
    ds_read_b64_tr_b16 v[126:127], v18 offset:15040
    s_waitcnt lgkmcnt(12)
    v_mfma_f32_16x16x32_bf16 v[24:27], v[100:103], v[168:171], v[24:27]
    ds_read_b64_tr_b16 v[96:97], v18 offset:10464
    v_mfma_f32_16x16x32_bf16 v[28:31], v[100:103], v[172:175], v[28:31]
    ds_read_b64_tr_b16 v[98:99], v18 offset:15072
    buffer_load_dwordx4 v[140:143], v16, s[12:15], s44 offen offset:1024
    s_waitcnt lgkmcnt(12)
    v_mfma_f32_16x16x32_bf16 v[32:35], v[104:107], v[168:171], v[32:35]
    ds_read_b64_tr_b16 v[100:101], v18 offset:10496
    v_mfma_f32_16x16x32_bf16 v[36:39], v[104:107], v[172:175], v[36:39]
    ds_read_b64_tr_b16 v[102:103], v18 offset:15104
    s_add_u32 s43, s43, 36864
    s_add_u32 m0, s42, 20480
    s_nop 0
    buffer_load_dwordx4 v6, s[8:11], s43 offen lds
    s_waitcnt lgkmcnt(12)
    v_mfma_f32_16x16x32_bf16 v[40:43], v[108:111], v[168:171], v[40:43]
    v_mfma_f32_16x16x32_bf16 v[44:47], v[108:111], v[172:175], v[44:47]
    s_add_u32 m0, s42, 24576
    s_nop 0
    buffer_load_dwordx4 v7, s[8:11], s43 offen lds
    s_waitcnt lgkmcnt(10)
    v_mfma_f32_16x16x32_bf16 v[48:51], v[112:115], v[168:171], v[48:51]
    v_mfma_f32_16x16x32_bf16 v[52:55], v[112:115], v[172:175], v[52:55]
    s_add_u32 m0, s50, 20480
    s_nop 0
    buffer_load_dwordx4 v8, s[8:11], s43 offen lds
    s_waitcnt lgkmcnt(8)
    v_mfma_f32_16x16x32_bf16 v[56:59], v[116:119], v[168:171], v[56:59]
    v_mfma_f32_16x16x32_bf16 v[60:63], v[116:119], v[172:175], v[60:63]
    buffer_load_dwordx4 v[144:147], v15, s[12:15], s44 offen offset:2048
    s_waitcnt lgkmcnt(6)
    v_mfma_f32_16x16x32_bf16 v[64:67], v[120:123], v[168:171], v[64:67]
    v_mfma_f32_16x16x32_bf16 v[68:71], v[120:123], v[172:175], v[68:71]
    buffer_load_dwordx4 v[148:151], v16, s[12:15], s44 offen offset:2048
    s_waitcnt lgkmcnt(4)
    v_mfma_f32_16x16x32_bf16 v[72:75], v[124:127], v[168:171], v[72:75]
    v_mfma_f32_16x16x32_bf16 v[76:79], v[124:127], v[172:175], v[76:79]
    s_add_u32 s43, s43, 36864
    s_add_u32 m0, s42, 30720
    s_nop 0
    buffer_load_dwordx4 v6, s[8:11], s43 offen lds
    s_waitcnt lgkmcnt(2)
    v_mfma_f32_16x16x32_bf16 v[80:83], v[96:99], v[168:171], v[80:83]
    v_mfma_f32_16x16x32_bf16 v[84:87], v[96:99], v[172:175], v[84:87]
    s_add_u32 m0, s42, 34816
    s_nop 0
    buffer_load_dwordx4 v7, s[8:11], s43 offen lds
    s_waitcnt lgkmcnt(0)
    v_mfma_f32_16x16x32_bf16 v[88:91], v[100:103], v[168:171], v[88:91]
    v_mfma_f32_16x16x32_bf16 v[92:95], v[100:103], v[172:175], v[92:95]
    s_add_u32 m0, s50, 30720
    s_nop 0
    buffer_load_dwordx4 v8, s[8:11], s43 offen lds
    s_waitcnt vmcnt(63)
    s_barrier
    ds_read_b64_tr_b16 v[104:105], v18 offset:20480
    ds_read_b64_tr_b16 v[106:107], v18 offset:25088
    ds_read_b64_tr_b16 v[108:109], v18 offset:20512
    ds_read_b64_tr_b16 v[110:111], v18 offset:25120
    ds_read_b64_tr_b16 v[112:113], v18 offset:20544
    ds_read_b64_tr_b16 v[114:115], v18 offset:25152
    ds_read_b64_tr_b16 v[116:117], v18 offset:20576
    ds_read_b64_tr_b16 v[118:119], v18 offset:25184
    ds_read_b64_tr_b16 v[120:121], v18 offset:20608
    ds_read_b64_tr_b16 v[122:123], v18 offset:25216
    ds_read_b64_tr_b16 v[124:125], v18 offset:20640
    ds_read_b64_tr_b16 v[126:127], v18 offset:25248
    ds_read_b64_tr_b16 v[96:97], v18 offset:20672
    ds_read_b64_tr_b16 v[98:99], v18 offset:25280
    s_waitcnt lgkmcnt(12)
    v_mfma_f32_16x16x32_bf16 v[24:27], v[104:107], v[176:179], v[24:27]
    ds_read_b64_tr_b16 v[100:101], v18 offset:20704
    v_mfma_f32_16x16x32_bf16 v[28:31], v[104:107], v[180:183], v[28:31]
    ds_read_b64_tr_b16 v[102:103], v18 offset:25312
    buffer_load_dwordx4 v[152:155], v15, s[12:15], s44 offen offset:3072
    s_waitcnt lgkmcnt(12)
    v_mfma_f32_16x16x32_bf16 v[32:35], v[108:111], v[176:179], v[32:35]
    ds_read_b64_tr_b16 v[104:105], v18 offset:20736
    v_mfma_f32_16x16x32_bf16 v[36:39], v[108:111], v[180:183], v[36:39]
    ds_read_b64_tr_b16 v[106:107], v18 offset:25344
    buffer_load_dwordx4 v[156:159], v16, s[12:15], s44 offen offset:3072
    s_waitcnt lgkmcnt(12)
    v_mfma_f32_16x16x32_bf16 v[40:43], v[112:115], v[176:179], v[40:43]
    v_mfma_f32_16x16x32_bf16 v[44:47], v[112:115], v[180:183], v[44:47]
    s_waitcnt lgkmcnt(10)
    v_mfma_f32_16x16x32_bf16 v[48:51], v[116:119], v[176:179], v[48:51]
    v_mfma_f32_16x16x32_bf16 v[52:55], v[116:119], v[180:183], v[52:55]
    s_waitcnt lgkmcnt(8)
    v_mfma_f32_16x16x32_bf16 v[56:59], v[120:123], v[176:179], v[56:59]
    v_mfma_f32_16x16x32_bf16 v[60:63], v[120:123], v[180:183], v[60:63]
    s_waitcnt lgkmcnt(6)
    v_mfma_f32_16x16x32_bf16 v[64:67], v[124:127], v[176:179], v[64:67]
    v_mfma_f32_16x16x32_bf16 v[68:71], v[124:127], v[180:183], v[68:71]
    s_waitcnt lgkmcnt(4)
    v_mfma_f32_16x16x32_bf16 v[72:75], v[96:99], v[176:179], v[72:75]
    v_mfma_f32_16x16x32_bf16 v[76:79], v[96:99], v[180:183], v[76:79]
    s_waitcnt lgkmcnt(2)
    v_mfma_f32_16x16x32_bf16 v[80:83], v[100:103], v[176:179], v[80:83]
    v_mfma_f32_16x16x32_bf16 v[84:87], v[100:103], v[180:183], v[84:87]
    s_waitcnt lgkmcnt(0)
    v_mfma_f32_16x16x32_bf16 v[88:91], v[104:107], v[176:179], v[88:91]
    v_mfma_f32_16x16x32_bf16 v[92:95], v[104:107], v[180:183], v[92:95]
    s_waitcnt vmcnt(60)
    s_barrier
    ds_read_b64_tr_b16 v[108:109], v18 offset:30720
    ds_read_b64_tr_b16 v[110:111], v18 offset:35328
    ds_read_b64_tr_b16 v[112:113], v18 offset:30752
    ds_read_b64_tr_b16 v[114:115], v18 offset:35360
    ds_read_b64_tr_b16 v[116:117], v18 offset:30784
    ds_read_b64_tr_b16 v[118:119], v18 offset:35392
    ds_read_b64_tr_b16 v[120:121], v18 offset:30816
    ds_read_b64_tr_b16 v[122:123], v18 offset:35424
    ds_read_b64_tr_b16 v[124:125], v18 offset:30848
    ds_read_b64_tr_b16 v[126:127], v18 offset:35456
    ds_read_b64_tr_b16 v[96:97], v18 offset:30880
    ds_read_b64_tr_b16 v[98:99], v18 offset:35488
    ds_read_b64_tr_b16 v[100:101], v18 offset:30912
    ds_read_b64_tr_b16 v[102:103], v18 offset:35520
    s_waitcnt lgkmcnt(12)
    v_mfma_f32_16x16x32_bf16 v[24:27], v[108:111], v[184:187], v[24:27]
    ds_read_b64_tr_b16 v[104:105], v18 offset:30944
    v_mfma_f32_16x16x32_bf16 v[28:31], v[108:111], v[188:191], v[28:31]
    ds_read_b64_tr_b16 v[106:107], v18 offset:35552
    s_waitcnt lgkmcnt(12)
    v_mfma_f32_16x16x32_bf16 v[32:35], v[112:115], v[184:187], v[32:35]
    ds_read_b64_tr_b16 v[108:109], v18 offset:30976
    v_mfma_f32_16x16x32_bf16 v[36:39], v[112:115], v[188:191], v[36:39]
    ds_read_b64_tr_b16 v[110:111], v18 offset:35584
    s_waitcnt lgkmcnt(12)
    v_mfma_f32_16x16x32_bf16 v[40:43], v[116:119], v[184:187], v[40:43]
    v_mfma_f32_16x16x32_bf16 v[44:47], v[116:119], v[188:191], v[44:47]
    s_waitcnt lgkmcnt(10)
    v_mfma_f32_16x16x32_bf16 v[48:51], v[120:123], v[184:187], v[48:51]
    v_mfma_f32_16x16x32_bf16 v[52:55], v[120:123], v[188:191], v[52:55]
    s_waitcnt lgkmcnt(8)
    v_mfma_f32_16x16x32_bf16 v[56:59], v[124:127], v[184:187], v[56:59]
    v_mfma_f32_16x16x32_bf16 v[60:63], v[124:127], v[188:191], v[60:63]
    s_waitcnt lgkmcnt(6)
    v_mfma_f32_16x16x32_bf16 v[64:67], v[96:99], v[184:187], v[64:67]
    v_mfma_f32_16x16x32_bf16 v[68:71], v[96:99], v[188:191], v[68:71]
    s_waitcnt lgkmcnt(4)
    v_mfma_f32_16x16x32_bf16 v[72:75], v[100:103], v[184:187], v[72:75]
    v_mfma_f32_16x16x32_bf16 v[76:79], v[100:103], v[188:191], v[76:79]
    s_waitcnt lgkmcnt(2)
    v_mfma_f32_16x16x32_bf16 v[80:83], v[104:107], v[184:187], v[80:83]
    v_mfma_f32_16x16x32_bf16 v[84:87], v[104:107], v[188:191], v[84:87]
    s_waitcnt lgkmcnt(0)
    v_mfma_f32_16x16x32_bf16 v[88:91], v[108:111], v[184:187], v[88:91]
    v_mfma_f32_16x16x32_bf16 v[92:95], v[108:111], v[188:191], v[92:95]
    s_waitcnt vmcnt(40)
    s_barrier
    v_add_u32 v18, 81920, v17
    ds_read_b64_tr_b16 v[96:97], v18 offset:0
    ds_read_b64_tr_b16 v[98:99], v18 offset:4608
    ds_read_b64_tr_b16 v[100:101], v18 offset:32
    ds_read_b64_tr_b16 v[102:103], v18 offset:4640
    ds_read_b64_tr_b16 v[104:105], v18 offset:64
    ds_read_b64_tr_b16 v[106:107], v18 offset:4672
    ds_read_b64_tr_b16 v[108:109], v18 offset:96
    ds_read_b64_tr_b16 v[110:111], v18 offset:4704
    ds_read_b64_tr_b16 v[112:113], v18 offset:128
    ds_read_b64_tr_b16 v[114:115], v18 offset:4736
    ds_read_b64_tr_b16 v[116:117], v18 offset:160
    ds_read_b64_tr_b16 v[118:119], v18 offset:4768
    ds_read_b64_tr_b16 v[120:121], v18 offset:192
    ds_read_b64_tr_b16 v[122:123], v18 offset:4800
    s_waitcnt lgkmcnt(12)
    v_mfma_f32_16x16x32_bf16 v[24:27], v[96:99], v[192:195], v[24:27]
    ds_read_b64_tr_b16 v[124:125], v18 offset:224
    v_mfma_f32_16x16x32_bf16 v[28:31], v[96:99], v[196:199], v[28:31]
    ds_read_b64_tr_b16 v[126:127], v18 offset:4832
    s_add_u32 s49, s48, 5
    s_and_b32 s49, s49, 7
    s_mul_i32 s43, s49, 147456
    s_lshl_b32 s44, s49, 12
    s_add_u32 m0, s42, 40960
    s_nop 0
    buffer_load_dwordx4 v6, s[8:11], s43 offen lds
    s_waitcnt lgkmcnt(12)
    v_mfma_f32_16x16x32_bf16 v[32:35], v[100:103], v[192:195], v[32:35]
    ds_read_b64_tr_b16 v[96:97], v18 offset:256
    v_mfma_f32_16x16x32_bf16 v[36:39], v[100:103], v[196:199], v[36:39]
    ds_read_b64_tr_b16 v[98:99], v18 offset:4864
    s_add_u32 m0, s42, 45056
    s_nop 0
    buffer_load_dwordx4 v7, s[8:11], s43 offen lds
    s_waitcnt lgkmcnt(12)
    v_mfma_f32_16x16x32_bf16 v[40:43], v[104:107], v[192:195], v[40:43]
    ds_read_b64_tr_b16 v[100:101], v18 offset:10240
    v_mfma_f32_16x16x32_bf16 v[44:47], v[104:107], v[196:199], v[44:47]
    ds_read_b64_tr_b16 v[102:103], v18 offset:14848
    s_add_u32 m0, s50, 40960
    s_nop 0
    buffer_load_dwordx4 v8, s[8:11], s43 offen lds
    s_waitcnt lgkmcnt(12)
    v_mfma_f32_16x16x32_bf16 v[48:51], v[108:111], v[192:195], v[48:51]
    ds_read_b64_tr_b16 v[104:105], v18 offset:10272
    v_mfma_f32_16x16x32_bf16 v[52:55], v[108:111], v[196:199], v[52:55]
    ds_read_b64_tr_b16 v[106:107], v18 offset:14880
    buffer_load_dwordx4 v[160:163], v15, s[12:15], s44 offen offset:0
    s_waitcnt lgkmcnt(12)
    v_mfma_f32_16x16x32_bf16 v[56:59], v[112:115], v[192:195], v[56:59]
    ds_read_b64_tr_b16 v[108:109], v18 offset:10304
    v_mfma_f32_16x16x32_bf16 v[60:63], v[112:115], v[196:199], v[60:63]
    ds_read_b64_tr_b16 v[110:111], v18 offset:14912
    buffer_load_dwordx4 v[164:167], v16, s[12:15], s44 offen offset:0
    s_waitcnt lgkmcnt(12)
    v_mfma_f32_16x16x32_bf16 v[64:67], v[116:119], v[192:195], v[64:67]
    ds_read_b64_tr_b16 v[112:113], v18 offset:10336
    v_mfma_f32_16x16x32_bf16 v[68:71], v[116:119], v[196:199], v[68:71]
    ds_read_b64_tr_b16 v[114:115], v18 offset:14944
    s_add_u32 s43, s43, 36864
    s_add_u32 m0, s42, 51200
    s_nop 0
    buffer_load_dwordx4 v6, s[8:11], s43 offen lds
    s_waitcnt lgkmcnt(12)
    v_mfma_f32_16x16x32_bf16 v[72:75], v[120:123], v[192:195], v[72:75]
    ds_read_b64_tr_b16 v[116:117], v18 offset:10368
    v_mfma_f32_16x16x32_bf16 v[76:79], v[120:123], v[196:199], v[76:79]
    ds_read_b64_tr_b16 v[118:119], v18 offset:14976
    s_add_u32 m0, s42, 55296
    s_nop 0
    buffer_load_dwordx4 v7, s[8:11], s43 offen lds
    s_waitcnt lgkmcnt(12)
    v_mfma_f32_16x16x32_bf16 v[80:83], v[124:127], v[192:195], v[80:83]
    ds_read_b64_tr_b16 v[120:121], v18 offset:10400
    v_mfma_f32_16x16x32_bf16 v[84:87], v[124:127], v[196:199], v[84:87]
    ds_read_b64_tr_b16 v[122:123], v18 offset:15008
    s_add_u32 m0, s50, 51200
    s_nop 0
    buffer_load_dwordx4 v8, s[8:11], s43 offen lds
    s_waitcnt lgkmcnt(12)
    v_mfma_f32_16x16x32_bf16 v[88:91], v[96:99], v[192:195], v[88:91]
    ds_read_b64_tr_b16 v[124:125], v18 offset:10432
    v_mfma_f32_16x16x32_bf16 v[92:95], v[96:99], v[196:199], v[92:95]
    ds_read_b64_tr_b16 v[126:127], v18 offset:15040
    buffer_load_dwordx4 v[168:171], v15, s[12:15], s44 offen offset:1024
    s_waitcnt lgkmcnt(12)
    v_mfma_f32_16x16x32_bf16 v[24:27], v[100:103], v[200:203], v[24:27]
    ds_read_b64_tr_b16 v[96:97], v18 offset:10464
    v_mfma_f32_16x16x32_bf16 v[28:31], v[100:103], v[204:207], v[28:31]
    ds_read_b64_tr_b16 v[98:99], v18 offset:15072
    buffer_load_dwordx4 v[172:175], v16, s[12:15], s44 offen offset:1024
    s_waitcnt lgkmcnt(12)
    v_mfma_f32_16x16x32_bf16 v[32:35], v[104:107], v[200:203], v[32:35]
    ds_read_b64_tr_b16 v[100:101], v18 offset:10496
    v_mfma_f32_16x16x32_bf16 v[36:39], v[104:107], v[204:207], v[36:39]
    ds_read_b64_tr_b16 v[102:103], v18 offset:15104
    s_add_u32 s43, s43, 36864
    s_add_u32 m0, s42, 61440
    s_nop 0
    buffer_load_dwordx4 v6, s[8:11], s43 offen lds
    s_waitcnt lgkmcnt(12)
    v_mfma_f32_16x16x32_bf16 v[40:43], v[108:111], v[200:203], v[40:43]
    ds_read_b64_tr_b16 v[104:105], v18 offset:20480
    v_mfma_f32_16x16x32_bf16 v[44:47], v[108:111], v[204:207], v[44:47]
    ds_read_b64_tr_b16 v[106:107], v18 offset:25088
    s_add_u32 m0, s42, 65536
    s_nop 0
    buffer_load_dwordx4 v7, s[8:11], s43 offen lds
    s_waitcnt lgkmcnt(12)
    v_mfma_f32_16x16x32_bf16 v[48:51], v[112:115], v[200:203], v[48:51]
    ds_read_b64_tr_b16 v[108:109], v18 offset:20512
    v_mfma_f32_16x16x32_bf16 v[52:55], v[112:115], v[204:207], v[52:55]
    ds_read_b64_tr_b16 v[110:111], v18 offset:25120
    s_add_u32 m0, s50, 61440
    s_nop 0
    buffer_load_dwordx4 v8, s[8:11], s43 offen lds
    s_waitcnt lgkmcnt(12)
    v_mfma_f32_16x16x32_bf16 v[56:59], v[116:119], v[200:203], v[56:59]
    ds_read_b64_tr_b16 v[112:113], v18 offset:20544
    v_mfma_f32_16x16x32_bf16 v[60:63], v[116:119], v[204:207], v[60:63]
    ds_read_b64_tr_b16 v[114:115], v18 offset:25152
    buffer_load_dwordx4 v[176:179], v15, s[12:15], s44 offen offset:2048
    s_waitcnt lgkmcnt(12)
    v_mfma_f32_16x16x32_bf16 v[64:67], v[120:123], v[200:203], v[64:67]
    ds_read_b64_tr_b16 v[116:117], v18 offset:20576
    v_mfma_f32_16x16x32_bf16 v[68:71], v[120:123], v[204:207], v[68:71]
    ds_read_b64_tr_b16 v[118:119], v18 offset:25184
    buffer_load_dwordx4 v[180:183], v16, s[12:15], s44 offen offset:2048
    s_waitcnt lgkmcnt(12)
    v_mfma_f32_16x16x32_bf16 v[72:75], v[124:127], v[200:203], v[72:75]
    ds_read_b64_tr_b16 v[120:121], v18 offset:20608
    v_mfma_f32_16x16x32_bf16 v[76:79], v[124:127], v[204:207], v[76:79]
    ds_read_b64_tr_b16 v[122:123], v18 offset:25216
    s_add_u32 s43, s43, 36864
    s_add_u32 m0, s42, 71680
    s_nop 0
    buffer_load_dwordx4 v6, s[8:11], s43 offen lds
    s_waitcnt lgkmcnt(12)
    v_mfma_f32_16x16x32_bf16 v[80:83], v[96:99], v[200:203], v[80:83]
    ds_read_b64_tr_b16 v[124:125], v18 offset:20640
    v_mfma_f32_16x16x32_bf16 v[84:87], v[96:99], v[204:207], v[84:87]
    ds_read_b64_tr_b16 v[126:127], v18 offset:25248
    s_add_u32 m0, s42, 75776
    s_nop 0
    buffer_load_dwordx4 v7, s[8:11], s43 offen lds
    s_waitcnt lgkmcnt(12)
    v_mfma_f32_16x16x32_bf16 v[88:91], v[100:103], v[200:203], v[88:91]
    ds_read_b64_tr_b16 v[96:97], v18 offset:20672
    v_mfma_f32_16x16x32_bf16 v[92:95], v[100:103], v[204:207], v[92:95]
    ds_read_b64_tr_b16 v[98:99], v18 offset:25280
    s_add_u32 m0, s50, 71680
    s_nop 0
    buffer_load_dwordx4 v8, s[8:11], s43 offen lds
    s_waitcnt lgkmcnt(12)
    v_mfma_f32_16x16x32_bf16 v[24:27], v[104:107], v[208:211], v[24:27]
    ds_read_b64_tr_b16 v[100:101], v18 offset:20704
    v_mfma_f32_16x16x32_bf16 v[28:31], v[104:107], v[212:215], v[28:31]
    ds_read_b64_tr_b16 v[102:103], v18 offset:25312
    buffer_load_dwordx4 v[184:187], v15, s[12:15], s44 offen offset:3072
    s_waitcnt lgkmcnt(12)
    v_mfma_f32_16x16x32_bf16 v[32:35], v[108:111], v[208:211], v[32:35]
    ds_read_b64_tr_b16 v[104:105], v18 offset:20736
    v_mfma_f32_16x16x32_bf16 v[36:39], v[108:111], v[212:215], v[36:39]
    ds_read_b64_tr_b16 v[106:107], v18 offset:25344
    buffer_load_dwordx4 v[188:191], v16, s[12:15], s44 offen offset:3072
    s_waitcnt lgkmcnt(12)
    v_mfma_f32_16x16x32_bf16 v[40:43], v[112:115], v[208:211], v[40:43]
    ds_read_b64_tr_b16 v[108:109], v18 offset:30720
    v_mfma_f32_16x16x32_bf16 v[44:47], v[112:115], v[212:215], v[44:47]
    ds_read_b64_tr_b16 v[110:111], v18 offset:35328
    s_waitcnt lgkmcnt(12)
    v_mfma_f32_16x16x32_bf16 v[48:51], v[116:119], v[208:211], v[48:51]
    ds_read_b64_tr_b16 v[112:113], v18 offset:30752
    v_mfma_f32_16x16x32_bf16 v[52:55], v[116:119], v[212:215], v[52:55]
    ds_read_b64_tr_b16 v[114:115], v18 offset:35360
    s_waitcnt lgkmcnt(12)
    v_mfma_f32_16x16x32_bf16 v[56:59], v[120:123], v[208:211], v[56:59]
    ds_read_b64_tr_b16 v[116:117], v18 offset:30784
    v_mfma_f32_16x16x32_bf16 v[60:63], v[120:123], v[212:215], v[60:63]
    ds_read_b64_tr_b16 v[118:119], v18 offset:35392
    s_waitcnt lgkmcnt(12)
    v_mfma_f32_16x16x32_bf16 v[64:67], v[124:127], v[208:211], v[64:67]
    ds_read_b64_tr_b16 v[120:121], v18 offset:30816
    v_mfma_f32_16x16x32_bf16 v[68:71], v[124:127], v[212:215], v[68:71]
    ds_read_b64_tr_b16 v[122:123], v18 offset:35424
    s_waitcnt lgkmcnt(12)
    v_mfma_f32_16x16x32_bf16 v[72:75], v[96:99], v[208:211], v[72:75]
    ds_read_b64_tr_b16 v[124:125], v18 offset:30848
    v_mfma_f32_16x16x32_bf16 v[76:79], v[96:99], v[212:215], v[76:79]
    ds_read_b64_tr_b16 v[126:127], v18 offset:35456
    s_waitcnt lgkmcnt(12)
    v_mfma_f32_16x16x32_bf16 v[80:83], v[100:103], v[208:211], v[80:83]
    ds_read_b64_tr_b16 v[96:97], v18 offset:30880
    v_mfma_f32_16x16x32_bf16 v[84:87], v[100:103], v[212:215], v[84:87]
    ds_read_b64_tr_b16 v[98:99], v18 offset:35488
    s_waitcnt lgkmcnt(12)
    v_mfma_f32_16x16x32_bf16 v[88:91], v[104:107], v[208:211], v[88:91]
    ds_read_b64_tr_b16 v[100:101], v18 offset:30912
    v_mfma_f32_16x16x32_bf16 v[92:95], v[104:107], v[212:215], v[92:95]
    ds_read_b64_tr_b16 v[102:103], v18 offset:35520
    s_waitcnt lgkmcnt(12)
    v_mfma_f32_16x16x32_bf16 v[24:27], v[108:111], v[216:219], v[24:27]
    ds_read_b64_tr_b16 v[104:105], v18 offset:30944
    v_mfma_f32_16x16x32_bf16 v[28:31], v[108:111], v[220:223], v[28:31]
    ds_read_b64_tr_b16 v[106:107], v18 offset:35552
    s_waitcnt lgkmcnt(12)
    v_mfma_f32_16x16x32_bf16 v[32:35], v[112:115], v[216:219], v[32:35]
    ds_read_b64_tr_b16 v[108:109], v18 offset:30976
    v_mfma_f32_16x16x32_bf16 v[36:39], v[112:115], v[220:223], v[36:39]
    ds_read_b64_tr_b16 v[110:111], v18 offset:35584
    s_waitcnt lgkmcnt(12)
    v_mfma_f32_16x16x32_bf16 v[40:43], v[116:119], v[216:219], v[40:43]
    v_mfma_f32_16x16x32_bf16 v[44:47], v[116:119], v[220:223], v[44:47]
    s_waitcnt lgkmcnt(10)
    v_mfma_f32_16x16x32_bf16 v[48:51], v[120:123], v[216:219], v[48:51]
    v_mfma_f32_16x16x32_bf16 v[52:55], v[120:123], v[220:223], v[52:55]
    s_waitcnt lgkmcnt(8)
    v_mfma_f32_16x16x32_bf16 v[56:59], v[124:127], v[216:219], v[56:59]
    v_mfma_f32_16x16x32_bf16 v[60:63], v[124:127], v[220:223], v[60:63]
    s_waitcnt lgkmcnt(6)
    v_mfma_f32_16x16x32_bf16 v[64:67], v[96:99], v[216:219], v[64:67]
    v_mfma_f32_16x16x32_bf16 v[68:71], v[96:99], v[220:223], v[68:71]
    s_waitcnt lgkmcnt(4)
    v_mfma_f32_16x16x32_bf16 v[72:75], v[100:103], v[216:219], v[72:75]
    v_mfma_f32_16x16x32_bf16 v[76:79], v[100:103], v[220:223], v[76:79]
    s_waitcnt lgkmcnt(2)
    v_mfma_f32_16x16x32_bf16 v[80:83], v[104:107], v[216:219], v[80:83]
    v_mfma_f32_16x16x32_bf16 v[84:87], v[104:107], v[220:223], v[84:87]
    s_waitcnt lgkmcnt(0)
    v_mfma_f32_16x16x32_bf16 v[88:91], v[108:111], v[216:219], v[88:91]
    v_mfma_f32_16x16x32_bf16 v[92:95], v[108:111], v[220:223], v[92:95]
    s_waitcnt vmcnt(40)
    s_barrier
    v_add_u32 v18, 122880, v17
    ds_read_b64_tr_b16 v[96:97], v18 offset:0
    ds_read_b64_tr_b16 v[98:99], v18 offset:4608
    ds_read_b64_tr_b16 v[100:101], v18 offset:32
    ds_read_b64_tr_b16 v[102:103], v18 offset:4640
    ds_read_b64_tr_b16 v[104:105], v18 offset:64
    ds_read_b64_tr_b16 v[106:107], v18 offset:4672
    ds_read_b64_tr_b16 v[108:109], v18 offset:96
    ds_read_b64_tr_b16 v[110:111], v18 offset:4704
    ds_read_b64_tr_b16 v[112:113], v18 offset:128
    ds_read_b64_tr_b16 v[114:115], v18 offset:4736
    ds_read_b64_tr_b16 v[116:117], v18 offset:160
    ds_read_b64_tr_b16 v[118:119], v18 offset:4768
    ds_read_b64_tr_b16 v[120:121], v18 offset:192
    ds_read_b64_tr_b16 v[122:123], v18 offset:4800
    s_waitcnt lgkmcnt(12)
    v_mfma_f32_16x16x32_bf16 v[24:27], v[96:99], v[224:227], v[24:27]
    ds_read_b64_tr_b16 v[124:125], v18 offset:224
    v_mfma_f32_16x16x32_bf16 v[28:31], v[96:99], v[228:231], v[28:31]
    ds_read_b64_tr_b16 v[126:127], v18 offset:4832
    s_add_u32 s49, s48, 6
    s_and_b32 s49, s49, 7
    s_mul_i32 s43, s49, 147456
    s_lshl_b32 s44, s49, 12
    s_add_u32 m0, s42, 81920
    s_nop 0
    buffer_load_dwordx4 v6, s[8:11], s43 offen lds
    s_waitcnt lgkmcnt(12)
    v_mfma_f32_16x16x32_bf16 v[32:35], v[100:103], v[224:227], v[32:35]
    ds_read_b64_tr_b16 v[96:97], v18 offset:256
    v_mfma_f32_16x16x32_bf16 v[36:39], v[100:103], v[228:231], v[36:39]
    ds_read_b64_tr_b16 v[98:99], v18 offset:4864
    s_add_u32 m0, s42, 86016
    s_nop 0
    buffer_load_dwordx4 v7, s[8:11], s43 offen lds
    s_waitcnt lgkmcnt(12)
    v_mfma_f32_16x16x32_bf16 v[40:43], v[104:107], v[224:227], v[40:43]
    ds_read_b64_tr_b16 v[100:101], v18 offset:10240
    v_mfma_f32_16x16x32_bf16 v[44:47], v[104:107], v[228:231], v[44:47]
    ds_read_b64_tr_b16 v[102:103], v18 offset:14848
    s_add_u32 m0, s50, 81920
    s_nop 0
    buffer_load_dwordx4 v8, s[8:11], s43 offen lds
    s_waitcnt lgkmcnt(12)
    v_mfma_f32_16x16x32_bf16 v[48:51], v[108:111], v[224:227], v[48:51]
    ds_read_b64_tr_b16 v[104:105], v18 offset:10272
    v_mfma_f32_16x16x32_bf16 v[52:55], v[108:111], v[228:231], v[52:55]
    ds_read_b64_tr_b16 v[106:107], v18 offset:14880
    buffer_load_dwordx4 v[192:195], v15, s[12:15], s44 offen offset:0
    s_waitcnt lgkmcnt(12)
    v_mfma_f32_16x16x32_bf16 v[56:59], v[112:115], v[224:227], v[56:59]
    ds_read_b64_tr_b16 v[108:109], v18 offset:10304
    v_mfma_f32_16x16x32_bf16 v[60:63], v[112:115], v[228:231], v[60:63]
    ds_read_b64_tr_b16 v[110:111], v18 offset:14912
    buffer_load_dwordx4 v[196:199], v16, s[12:15], s44 offen offset:0
    s_waitcnt lgkmcnt(12)
    v_mfma_f32_16x16x32_bf16 v[64:67], v[116:119], v[224:227], v[64:67]
    ds_read_b64_tr_b16 v[112:113], v18 offset:10336
    v_mfma_f32_16x16x32_bf16 v[68:71], v[116:119], v[228:231], v[68:71]
    ds_read_b64_tr_b16 v[114:115], v18 offset:14944
    s_add_u32 s43, s43, 36864
    s_add_u32 m0, s42, 92160
    s_nop 0
    buffer_load_dwordx4 v6, s[8:11], s43 offen lds
    s_waitcnt lgkmcnt(12)
    v_mfma_f32_16x16x32_bf16 v[72:75], v[120:123], v[224:227], v[72:75]
    ds_read_b64_tr_b16 v[116:117], v18 offset:10368
    v_mfma_f32_16x16x32_bf16 v[76:79], v[120:123], v[228:231], v[76:79]
    ds_read_b64_tr_b16 v[118:119], v18 offset:14976
    s_add_u32 m0, s42, 96256
    s_nop 0
    buffer_load_dwordx4 v7, s[8:11], s43 offen lds
    s_waitcnt lgkmcnt(12)
    v_mfma_f32_16x16x32_bf16 v[80:83], v[124:127], v[224:227], v[80:83]
    ds_read_b64_tr_b16 v[120:121], v18 offset:10400
    v_mfma_f32_16x16x32_bf16 v[84:87], v[124:127], v[228:231], v[84:87]
    ds_read_b64_tr_b16 v[122:123], v18 offset:15008
    s_add_u32 m0, s50, 92160
    s_nop 0
    buffer_load_dwordx4 v8, s[8:11], s43 offen lds
    s_waitcnt lgkmcnt(12)
    v_mfma_f32_16x16x32_bf16 v[88:91], v[96:99], v[224:227], v[88:91]
    ds_read_b64_tr_b16 v[124:125], v18 offset:10432
    v_mfma_f32_16x16x32_bf16 v[92:95], v[96:99], v[228:231], v[92:95]
    ds_read_b64_tr_b16 v[126:127], v18 offset:15040
    buffer_load_dwordx4 v[200:203], v15, s[12:15], s44 offen offset:1024
    s_waitcnt lgkmcnt(12)
    v_mfma_f32_16x16x32_bf16 v[24:27], v[100:103], v[232:235], v[24:27]
    ds_read_b64_tr_b16 v[96:97], v18 offset:10464
    v_mfma_f32_16x16x32_bf16 v[28:31], v[100:103], v[236:239], v[28:31]
    ds_read_b64_tr_b16 v[98:99], v18 offset:15072
    buffer_load_dwordx4 v[204:207], v16, s[12:15], s44 offen offset:1024
    s_waitcnt lgkmcnt(12)
    v_mfma_f32_16x16x32_bf16 v[32:35], v[104:107], v[232:235], v[32:35]
    ds_read_b64_tr_b16 v[100:101], v18 offset:10496
    v_mfma_f32_16x16x32_bf16 v[36:39], v[104:107], v[236:239], v[36:39]
    ds_read_b64_tr_b16 v[102:103], v18 offset:15104
    s_add_u32 s43, s43, 36864
    s_add_u32 m0, s42, 102400
    s_nop 0
    buffer_load_dwordx4 v6, s[8:11], s43 offen lds
    s_waitcnt lgkmcnt(12)
    v_mfma_f32_16x16x32_bf16 v[40:43], v[108:111], v[232:235], v[40:43]
    ds_read_b64_tr_b16 v[104:105], v18 offset:20480
    v_mfma_f32_16x16x32_bf16 v[44:47], v[108:111], v[236:239], v[44:47]
    ds_read_b64_tr_b16 v[106:107], v18 offset:25088
    s_add_u32 m0, s42, 106496
    s_nop 0
    buffer_load_dwordx4 v7, s[8:11], s43 offen lds
    s_waitcnt lgkmcnt(12)
    v_mfma_f32_16x16x32_bf16 v[48:51], v[112:115], v[232:235], v[48:51]
    ds_read_b64_tr_b16 v[108:109], v18 offset:20512
    v_mfma_f32_16x16x32_bf16 v[52:55], v[112:115], v[236:239], v[52:55]
    ds_read_b64_tr_b16 v[110:111], v18 offset:25120
    s_add_u32 m0, s50, 102400
    s_nop 0
    buffer_load_dwordx4 v8, s[8:11], s43 offen lds
    s_waitcnt lgkmcnt(12)
    v_mfma_f32_16x16x32_bf16 v[56:59], v[116:119], v[232:235], v[56:59]
    ds_read_b64_tr_b16 v[112:113], v18 offset:20544
    v_mfma_f32_16x16x32_bf16 v[60:63], v[116:119], v[236:239], v[60:63]
    ds_read_b64_tr_b16 v[114:115], v18 offset:25152
    buffer_load_dwordx4 v[208:211], v15, s[12:15], s44 offen offset:2048
    s_waitcnt lgkmcnt(12)
    v_mfma_f32_16x16x32_bf16 v[64:67], v[120:123], v[232:235], v[64:67]
    ds_read_b64_tr_b16 v[116:117], v18 offset:20576
    v_mfma_f32_16x16x32_bf16 v[68:71], v[120:123], v[236:239], v[68:71]
    ds_read_b64_tr_b16 v[118:119], v18 offset:25184
    buffer_load_dwordx4 v[212:215], v16, s[12:15], s44 offen offset:2048
    s_waitcnt lgkmcnt(12)
    v_mfma_f32_16x16x32_bf16 v[72:75], v[124:127], v[232:235], v[72:75]
    ds_read_b64_tr_b16 v[120:121], v18 offset:20608
    v_mfma_f32_16x16x32_bf16 v[76:79], v[124:127], v[236:239], v[76:79]
    ds_read_b64_tr_b16 v[122:123], v18 offset:25216
    s_add_u32 s43, s43, 36864
    s_add_u32 m0, s42, 112640
    s_nop 0
    buffer_load_dwordx4 v6, s[8:11], s43 offen lds
    s_waitcnt lgkmcnt(12)
    v_mfma_f32_16x16x32_bf16 v[80:83], v[96:99], v[232:235], v[80:83]
    ds_read_b64_tr_b16 v[124:125], v18 offset:20640
    v_mfma_f32_16x16x32_bf16 v[84:87], v[96:99], v[236:239], v[84:87]
    ds_read_b64_tr_b16 v[126:127], v18 offset:25248
    s_add_u32 m0, s42, 116736
    s_nop 0
    buffer_load_dwordx4 v7, s[8:11], s43 offen lds
    s_waitcnt lgkmcnt(12)
    v_mfma_f32_16x16x32_bf16 v[88:91], v[100:103], v[232:235], v[88:91]
    ds_read_b64_tr_b16 v[96:97], v18 offset:20672
    v_mfma_f32_16x16x32_bf16 v[92:95], v[100:103], v[236:239], v[92:95]
    ds_read_b64_tr_b16 v[98:99], v18 offset:25280
    s_add_u32 m0, s50, 112640
    s_nop 0
    buffer_load_dwordx4 v8, s[8:11], s43 offen lds
    s_waitcnt lgkmcnt(12)
    v_mfma_f32_16x16x32_bf16 v[24:27], v[104:107], v[240:243], v[24:27]
    ds_read_b64_tr_b16 v[100:101], v18 offset:20704
    v_mfma_f32_16x16x32_bf16 v[28:31], v[104:107], v[244:247], v[28:31]
    ds_read_b64_tr_b16 v[102:103], v18 offset:25312
    buffer_load_dwordx4 v[216:219], v15, s[12:15], s44 offen offset:3072
    s_waitcnt lgkmcnt(12)
    v_mfma_f32_16x16x32_bf16 v[32:35], v[108:111], v[240:243], v[32:35]
    ds_read_b64_tr_b16 v[104:105], v18 offset:20736
    v_mfma_f32_16x16x32_bf16 v[36:39], v[108:111], v[244:247], v[36:39]
    ds_read_b64_tr_b16 v[106:107], v18 offset:25344
    buffer_load_dwordx4 v[220:223], v16, s[12:15], s44 offen offset:3072
    s_waitcnt lgkmcnt(12)
    v_mfma_f32_16x16x32_bf16 v[40:43], v[112:115], v[240:243], v[40:43]
    ds_read_b64_tr_b16 v[108:109], v18 offset:30720
    v_mfma_f32_16x16x32_bf16 v[44:47], v[112:115], v[244:247], v[44:47]
    ds_read_b64_tr_b16 v[110:111], v18 offset:35328
    s_waitcnt lgkmcnt(12)
    v_mfma_f32_16x16x32_bf16 v[48:51], v[116:119], v[240:243], v[48:51]
    ds_read_b64_tr_b16 v[112:113], v18 offset:30752
    v_mfma_f32_16x16x32_bf16 v[52:55], v[116:119], v[244:247], v[52:55]
    ds_read_b64_tr_b16 v[114:115], v18 offset:35360
    s_waitcnt lgkmcnt(12)
    v_mfma_f32_16x16x32_bf16 v[56:59], v[120:123], v[240:243], v[56:59]
    ds_read_b64_tr_b16 v[116:117], v18 offset:30784
    v_mfma_f32_16x16x32_bf16 v[60:63], v[120:123], v[244:247], v[60:63]
    ds_read_b64_tr_b16 v[118:119], v18 offset:35392
    s_waitcnt lgkmcnt(12)
    v_mfma_f32_16x16x32_bf16 v[64:67], v[124:127], v[240:243], v[64:67]
    ds_read_b64_tr_b16 v[120:121], v18 offset:30816
    v_mfma_f32_16x16x32_bf16 v[68:71], v[124:127], v[244:247], v[68:71]
    ds_read_b64_tr_b16 v[122:123], v18 offset:35424
    s_waitcnt lgkmcnt(12)
    v_mfma_f32_16x16x32_bf16 v[72:75], v[96:99], v[240:243], v[72:75]
    ds_read_b64_tr_b16 v[124:125], v18 offset:30848
    v_mfma_f32_16x16x32_bf16 v[76:79], v[96:99], v[244:247], v[76:79]
    ds_read_b64_tr_b16 v[126:127], v18 offset:35456
    s_waitcnt lgkmcnt(12)
    v_mfma_f32_16x16x32_bf16 v[80:83], v[100:103], v[240:243], v[80:83]
    ds_read_b64_tr_b16 v[96:97], v18 offset:30880
    v_mfma_f32_16x16x32_bf16 v[84:87], v[100:103], v[244:247], v[84:87]
    ds_read_b64_tr_b16 v[98:99], v18 offset:35488
    s_waitcnt lgkmcnt(12)
    v_mfma_f32_16x16x32_bf16 v[88:91], v[104:107], v[240:243], v[88:91]
    ds_read_b64_tr_b16 v[100:101], v18 offset:30912
    v_mfma_f32_16x16x32_bf16 v[92:95], v[104:107], v[244:247], v[92:95]
    ds_read_b64_tr_b16 v[102:103], v18 offset:35520
    s_waitcnt lgkmcnt(12)
    v_mfma_f32_16x16x32_bf16 v[24:27], v[108:111], v[248:251], v[24:27]
    ds_read_b64_tr_b16 v[104:105], v18 offset:30944
    v_mfma_f32_16x16x32_bf16 v[28:31], v[108:111], v[252:255], v[28:31]
    ds_read_b64_tr_b16 v[106:107], v18 offset:35552
    s_waitcnt lgkmcnt(12)
    v_mfma_f32_16x16x32_bf16 v[32:35], v[112:115], v[248:251], v[32:35]
    ds_read_b64_tr_b16 v[108:109], v18 offset:30976
    v_mfma_f32_16x16x32_bf16 v[36:39], v[112:115], v[252:255], v[36:39]
    ds_read_b64_tr_b16 v[110:111], v18 offset:35584
    s_waitcnt lgkmcnt(12)
    v_mfma_f32_16x16x32_bf16 v[40:43], v[116:119], v[248:251], v[40:43]
    v_mfma_f32_16x16x32_bf16 v[44:47], v[116:119], v[252:255], v[44:47]
    s_waitcnt lgkmcnt(10)
    v_mfma_f32_16x16x32_bf16 v[48:51], v[120:123], v[248:251], v[48:51]
    v_mfma_f32_16x16x32_bf16 v[52:55], v[120:123], v[252:255], v[52:55]
    s_waitcnt lgkmcnt(8)
    v_mfma_f32_16x16x32_bf16 v[56:59], v[124:127], v[248:251], v[56:59]
    v_mfma_f32_16x16x32_bf16 v[60:63], v[124:127], v[252:255], v[60:63]
    s_waitcnt lgkmcnt(6)
    v_mfma_f32_16x16x32_bf16 v[64:67], v[96:99], v[248:251], v[64:67]
    v_mfma_f32_16x16x32_bf16 v[68:71], v[96:99], v[252:255], v[68:71]
    s_waitcnt lgkmcnt(4)
    v_mfma_f32_16x16x32_bf16 v[72:75], v[100:103], v[248:251], v[72:75]
    v_mfma_f32_16x16x32_bf16 v[76:79], v[100:103], v[252:255], v[76:79]
    s_waitcnt lgkmcnt(2)
    v_mfma_f32_16x16x32_bf16 v[80:83], v[104:107], v[248:251], v[80:83]
    v_mfma_f32_16x16x32_bf16 v[84:87], v[104:107], v[252:255], v[84:87]
    s_waitcnt lgkmcnt(0)
    v_mfma_f32_16x16x32_bf16 v[88:91], v[108:111], v[248:251], v[88:91]
    v_mfma_f32_16x16x32_bf16 v[92:95], v[108:111], v[252:255], v[92:95]
    s_waitcnt vmcnt(40)
    s_barrier
    v_add_u32 v18, 0, v17
    ds_read_b64_tr_b16 v[96:97], v18 offset:0
    ds_read_b64_tr_b16 v[98:99], v18 offset:4608
    ds_read_b64_tr_b16 v[100:101], v18 offset:32
    ds_read_b64_tr_b16 v[102:103], v18 offset:4640
    ds_read_b64_tr_b16 v[104:105], v18 offset:64
    ds_read_b64_tr_b16 v[106:107], v18 offset:4672
    ds_read_b64_tr_b16 v[108:109], v18 offset:96
    ds_read_b64_tr_b16 v[110:111], v18 offset:4704
    ds_read_b64_tr_b16 v[112:113], v18 offset:128
    ds_read_b64_tr_b16 v[114:115], v18 offset:4736
    ds_read_b64_tr_b16 v[116:117], v18 offset:160
    ds_read_b64_tr_b16 v[118:119], v18 offset:4768
    ds_read_b64_tr_b16 v[120:121], v18 offset:192
    ds_read_b64_tr_b16 v[122:123], v18 offset:4800
    s_waitcnt lgkmcnt(12)
    v_mfma_f32_16x16x32_bf16 v[24:27], v[96:99], v[128:131], v[24:27]
    ds_read_b64_tr_b16 v[124:125], v18 offset:224
    v_mfma_f32_16x16x32_bf16 v[28:31], v[96:99], v[132:135], v[28:31]
    ds_read_b64_tr_b16 v[126:127], v18 offset:4832
    s_add_u32 s49, s48, 7
    s_and_b32 s49, s49, 7
    s_mul_i32 s43, s49, 147456
    s_lshl_b32 s44, s49, 12
    s_add_u32 m0, s42, 122880
    s_nop 0
    buffer_load_dwordx4 v6, s[8:11], s43 offen lds
    s_waitcnt lgkmcnt(12)
    v_mfma_f32_16x16x32_bf16 v[32:35], v[100:103], v[128:131], v[32:35]
    ds_read_b64_tr_b16 v[96:97], v18 offset:256
    v_mfma_f32_16x16x32_bf16 v[36:39], v[100:103], v[132:135], v[36:39]
    ds_read_b64_tr_b16 v[98:99], v18 offset:4864
    s_add_u32 m0, s42, 126976
    s_nop 0
    buffer_load_dwordx4 v7, s[8:11], s43 offen lds
    s_waitcnt lgkmcnt(12)
    v_mfma_f32_16x16x32_bf16 v[40:43], v[104:107], v[128:131], v[40:43]
    ds_read_b64_tr_b16 v[100:101], v18 offset:10240
    v_mfma_f32_16x16x32_bf16 v[44:47], v[104:107], v[132:135], v[44:47]
    ds_read_b64_tr_b16 v[102:103], v18 offset:14848
    s_add_u32 m0, s50, 122880
    s_nop 0
    buffer_load_dwordx4 v8, s[8:11], s43 offen lds
    s_waitcnt lgkmcnt(12)
    v_mfma_f32_16x16x32_bf16 v[48:51], v[108:111], v[128:131], v[48:51]
    ds_read_b64_tr_b16 v[104:105], v18 offset:10272
    v_mfma_f32_16x16x32_bf16 v[52:55], v[108:111], v[132:135], v[52:55]
    ds_read_b64_tr_b16 v[106:107], v18 offset:14880
    buffer_load_dwordx4 v[224:227], v15, s[12:15], s44 offen offset:0
    s_waitcnt lgkmcnt(12)
    v_mfma_f32_16x16x32_bf16 v[56:59], v[112:115], v[128:131], v[56:59]
    ds_read_b64_tr_b16 v[108:109], v18 offset:10304
    v_mfma_f32_16x16x32_bf16 v[60:63], v[112:115], v[132:135], v[60:63]
    ds_read_b64_tr_b16 v[110:111], v18 offset:14912
    buffer_load_dwordx4 v[228:231], v16, s[12:15], s44 offen offset:0
    s_waitcnt lgkmcnt(12)
    v_mfma_f32_16x16x32_bf16 v[64:67], v[116:119], v[128:131], v[64:67]
    ds_read_b64_tr_b16 v[112:113], v18 offset:10336
    v_mfma_f32_16x16x32_bf16 v[68:71], v[116:119], v[132:135], v[68:71]
    ds_read_b64_tr_b16 v[114:115], v18 offset:14944
    s_add_u32 s43, s43, 36864
    s_add_u32 m0, s42, 133120
    s_nop 0
    buffer_load_dwordx4 v6, s[8:11], s43 offen lds
    s_waitcnt lgkmcnt(12)
    v_mfma_f32_16x16x32_bf16 v[72:75], v[120:123], v[128:131], v[72:75]
    ds_read_b64_tr_b16 v[116:117], v18 offset:10368
    v_mfma_f32_16x16x32_bf16 v[76:79], v[120:123], v[132:135], v[76:79]
    ds_read_b64_tr_b16 v[118:119], v18 offset:14976
    s_add_u32 m0, s42, 137216
    s_nop 0
    buffer_load_dwordx4 v7, s[8:11], s43 offen lds
    s_waitcnt lgkmcnt(12)
    v_mfma_f32_16x16x32_bf16 v[80:83], v[124:127], v[128:131], v[80:83]
    ds_read_b64_tr_b16 v[120:121], v18 offset:10400
    v_mfma_f32_16x16x32_bf16 v[84:87], v[124:127], v[132:135], v[84:87]
    ds_read_b64_tr_b16 v[122:123], v18 offset:15008
    s_add_u32 m0, s50, 133120
    s_nop 0
    buffer_load_dwordx4 v8, s[8:11], s43 offen lds
    s_waitcnt lgkmcnt(12)
    v_mfma_f32_16x16x32_bf16 v[88:91], v[96:99], v[128:131], v[88:91]
    ds_read_b64_tr_b16 v[124:125], v18 offset:10432
    v_mfma_f32_16x16x32_bf16 v[92:95], v[96:99], v[132:135], v[92:95]
    ds_read_b64_tr_b16 v[126:127], v18 offset:15040
    buffer_load_dwordx4 v[232:235], v15, s[12:15], s44 offen offset:1024
    s_waitcnt lgkmcnt(12)
    v_mfma_f32_16x16x32_bf16 v[24:27], v[100:103], v[136:139], v[24:27]
    ds_read_b64_tr_b16 v[96:97], v18 offset:10464
    v_mfma_f32_16x16x32_bf16 v[28:31], v[100:103], v[140:143], v[28:31]
    ds_read_b64_tr_b16 v[98:99], v18 offset:15072
    buffer_load_dwordx4 v[236:239], v16, s[12:15], s44 offen offset:1024
    s_waitcnt lgkmcnt(12)
    v_mfma_f32_16x16x32_bf16 v[32:35], v[104:107], v[136:139], v[32:35]
    ds_read_b64_tr_b16 v[100:101], v18 offset:10496
    v_mfma_f32_16x16x32_bf16 v[36:39], v[104:107], v[140:143], v[36:39]
    ds_read_b64_tr_b16 v[102:103], v18 offset:15104
    s_add_u32 s43, s43, 36864
    s_add_u32 m0, s42, 143360
    s_nop 0
    buffer_load_dwordx4 v6, s[8:11], s43 offen lds
    s_waitcnt lgkmcnt(12)
    v_mfma_f32_16x16x32_bf16 v[40:43], v[108:111], v[136:139], v[40:43]
    ds_read_b64_tr_b16 v[104:105], v18 offset:20480
    v_mfma_f32_16x16x32_bf16 v[44:47], v[108:111], v[140:143], v[44:47]
    ds_read_b64_tr_b16 v[106:107], v18 offset:25088
    s_add_u32 m0, s42, 147456
    s_nop 0
    buffer_load_dwordx4 v7, s[8:11], s43 offen lds
    s_waitcnt lgkmcnt(12)
    v_mfma_f32_16x16x32_bf16 v[48:51], v[112:115], v[136:139], v[48:51]
    ds_read_b64_tr_b16 v[108:109], v18 offset:20512
    v_mfma_f32_16x16x32_bf16 v[52:55], v[112:115], v[140:143], v[52:55]
    ds_read_b64_tr_b16 v[110:111], v18 offset:25120
    s_add_u32 m0, s50, 143360
    s_nop 0
    buffer_load_dwordx4 v8, s[8:11], s43 offen lds
    s_waitcnt lgkmcnt(12)
    v_mfma_f32_16x16x32_bf16 v[56:59], v[116:119], v[136:139], v[56:59]
    ds_read_b64_tr_b16 v[112:113], v18 offset:20544
    v_mfma_f32_16x16x32_bf16 v[60:63], v[116:119], v[140:143], v[60:63]
    ds_read_b64_tr_b16 v[114:115], v18 offset:25152
    buffer_load_dwordx4 v[240:243], v15, s[12:15], s44 offen offset:2048
    s_waitcnt lgkmcnt(12)
    v_mfma_f32_16x16x32_bf16 v[64:67], v[120:123], v[136:139], v[64:67]
    ds_read_b64_tr_b16 v[116:117], v18 offset:20576
    v_mfma_f32_16x16x32_bf16 v[68:71], v[120:123], v[140:143], v[68:71]
    ds_read_b64_tr_b16 v[118:119], v18 offset:25184
    buffer_load_dwordx4 v[244:247], v16, s[12:15], s44 offen offset:2048
    s_waitcnt lgkmcnt(12)
    v_mfma_f32_16x16x32_bf16 v[72:75], v[124:127], v[136:139], v[72:75]
    ds_read_b64_tr_b16 v[120:121], v18 offset:20608
    v_mfma_f32_16x16x32_bf16 v[76:79], v[124:127], v[140:143], v[76:79]
    ds_read_b64_tr_b16 v[122:123], v18 offset:25216
    s_add_u32 s43, s43, 36864
    s_add_u32 m0, s42, 153600
    s_nop 0
    buffer_load_dwordx4 v6, s[8:11], s43 offen lds
    s_waitcnt lgkmcnt(12)
    v_mfma_f32_16x16x32_bf16 v[80:83], v[96:99], v[136:139], v[80:83]
    ds_read_b64_tr_b16 v[124:125], v18 offset:20640
    v_mfma_f32_16x16x32_bf16 v[84:87], v[96:99], v[140:143], v[84:87]
    ds_read_b64_tr_b16 v[126:127], v18 offset:25248
    s_add_u32 m0, s42, 157696
    s_nop 0
    buffer_load_dwordx4 v7, s[8:11], s43 offen lds
    s_waitcnt lgkmcnt(12)
    v_mfma_f32_16x16x32_bf16 v[88:91], v[100:103], v[136:139], v[88:91]
    ds_read_b64_tr_b16 v[96:97], v18 offset:20672
    v_mfma_f32_16x16x32_bf16 v[92:95], v[100:103], v[140:143], v[92:95]
    ds_read_b64_tr_b16 v[98:99], v18 offset:25280
    s_add_u32 m0, s50, 153600
    s_nop 0
    buffer_load_dwordx4 v8, s[8:11], s43 offen lds
    s_waitcnt lgkmcnt(12)
    v_mfma_f32_16x16x32_bf16 v[24:27], v[104:107], v[144:147], v[24:27]
    ds_read_b64_tr_b16 v[100:101], v18 offset:20704
    v_mfma_f32_16x16x32_bf16 v[28:31], v[104:107], v[148:151], v[28:31]
    ds_read_b64_tr_b16 v[102:103], v18 offset:25312
    buffer_load_dwordx4 v[248:251], v15, s[12:15], s44 offen offset:3072
    s_waitcnt lgkmcnt(12)
    v_mfma_f32_16x16x32_bf16 v[32:35], v[108:111], v[144:147], v[32:35]
    ds_read_b64_tr_b16 v[104:105], v18 offset:20736
    v_mfma_f32_16x16x32_bf16 v[36:39], v[108:111], v[148:151], v[36:39]
    ds_read_b64_tr_b16 v[106:107], v18 offset:25344
    buffer_load_dwordx4 v[252:255], v16, s[12:15], s44 offen offset:3072
    s_waitcnt lgkmcnt(12)
    v_mfma_f32_16x16x32_bf16 v[40:43], v[112:115], v[144:147], v[40:43]
    ds_read_b64_tr_b16 v[108:109], v18 offset:30720
    v_mfma_f32_16x16x32_bf16 v[44:47], v[112:115], v[148:151], v[44:47]
    ds_read_b64_tr_b16 v[110:111], v18 offset:35328
    s_waitcnt lgkmcnt(12)
    v_mfma_f32_16x16x32_bf16 v[48:51], v[116:119], v[144:147], v[48:51]
    ds_read_b64_tr_b16 v[112:113], v18 offset:30752
    v_mfma_f32_16x16x32_bf16 v[52:55], v[116:119], v[148:151], v[52:55]
    ds_read_b64_tr_b16 v[114:115], v18 offset:35360
    s_waitcnt lgkmcnt(12)
    v_mfma_f32_16x16x32_bf16 v[56:59], v[120:123], v[144:147], v[56:59]
    ds_read_b64_tr_b16 v[116:117], v18 offset:30784
    v_mfma_f32_16x16x32_bf16 v[60:63], v[120:123], v[148:151], v[60:63]
    ds_read_b64_tr_b16 v[118:119], v18 offset:35392
    s_waitcnt lgkmcnt(12)
    v_mfma_f32_16x16x32_bf16 v[64:67], v[124:127], v[144:147], v[64:67]
    ds_read_b64_tr_b16 v[120:121], v18 offset:30816
    v_mfma_f32_16x16x32_bf16 v[68:71], v[124:127], v[148:151], v[68:71]
    ds_read_b64_tr_b16 v[122:123], v18 offset:35424
    s_waitcnt lgkmcnt(12)
    v_mfma_f32_16x16x32_bf16 v[72:75], v[96:99], v[144:147], v[72:75]
    ds_read_b64_tr_b16 v[124:125], v18 offset:30848
    v_mfma_f32_16x16x32_bf16 v[76:79], v[96:99], v[148:151], v[76:79]
    ds_read_b64_tr_b16 v[126:127], v18 offset:35456
    s_waitcnt lgkmcnt(12)
    v_mfma_f32_16x16x32_bf16 v[80:83], v[100:103], v[144:147], v[80:83]
    ds_read_b64_tr_b16 v[96:97], v18 offset:30880
    v_mfma_f32_16x16x32_bf16 v[84:87], v[100:103], v[148:151], v[84:87]
    ds_read_b64_tr_b16 v[98:99], v18 offset:35488
    s_waitcnt lgkmcnt(12)
    v_mfma_f32_16x16x32_bf16 v[88:91], v[104:107], v[144:147], v[88:91]
    ds_read_b64_tr_b16 v[100:101], v18 offset:30912
    v_mfma_f32_16x16x32_bf16 v[92:95], v[104:107], v[148:151], v[92:95]
    ds_read_b64_tr_b16 v[102:103], v18 offset:35520
    s_waitcnt lgkmcnt(12)
    v_mfma_f32_16x16x32_bf16 v[24:27], v[108:111], v[152:155], v[24:27]
    ds_read_b64_tr_b16 v[104:105], v18 offset:30944
    v_mfma_f32_16x16x32_bf16 v[28:31], v[108:111], v[156:159], v[28:31]
    ds_read_b64_tr_b16 v[106:107], v18 offset:35552
    s_waitcnt lgkmcnt(12)
    v_mfma_f32_16x16x32_bf16 v[32:35], v[112:115], v[152:155], v[32:35]
    ds_read_b64_tr_b16 v[108:109], v18 offset:30976
    v_mfma_f32_16x16x32_bf16 v[36:39], v[112:115], v[156:159], v[36:39]
    ds_read_b64_tr_b16 v[110:111], v18 offset:35584
    s_waitcnt lgkmcnt(12)
    v_mfma_f32_16x16x32_bf16 v[40:43], v[116:119], v[152:155], v[40:43]
    v_mfma_f32_16x16x32_bf16 v[44:47], v[116:119], v[156:159], v[44:47]
    s_waitcnt lgkmcnt(10)
    v_mfma_f32_16x16x32_bf16 v[48:51], v[120:123], v[152:155], v[48:51]
    v_mfma_f32_16x16x32_bf16 v[52:55], v[120:123], v[156:159], v[52:55]
    s_waitcnt lgkmcnt(8)
    v_mfma_f32_16x16x32_bf16 v[56:59], v[124:127], v[152:155], v[56:59]
    v_mfma_f32_16x16x32_bf16 v[60:63], v[124:127], v[156:159], v[60:63]
    s_waitcnt lgkmcnt(6)
    v_mfma_f32_16x16x32_bf16 v[64:67], v[96:99], v[152:155], v[64:67]
    v_mfma_f32_16x16x32_bf16 v[68:71], v[96:99], v[156:159], v[68:71]
    s_waitcnt lgkmcnt(4)
    v_mfma_f32_16x16x32_bf16 v[72:75], v[100:103], v[152:155], v[72:75]
    v_mfma_f32_16x16x32_bf16 v[76:79], v[100:103], v[156:159], v[76:79]
    s_waitcnt lgkmcnt(2)
    v_mfma_f32_16x16x32_bf16 v[80:83], v[104:107], v[152:155], v[80:83]
    v_mfma_f32_16x16x32_bf16 v[84:87], v[104:107], v[156:159], v[84:87]
    s_waitcnt lgkmcnt(0)
    v_mfma_f32_16x16x32_bf16 v[88:91], v[108:111], v[152:155], v[88:91]
    v_mfma_f32_16x16x32_bf16 v[92:95], v[108:111], v[156:159], v[92:95]
    s_waitcnt vmcnt(40)
    s_barrier
    v_add_u32 v18, 40960, v17
    ds_read_b64_tr_b16 v[96:97], v18 offset:0
    ds_read_b64_tr_b16 v[98:99], v18 offset:4608
    ds_read_b64_tr_b16 v[100:101], v18 offset:32
    ds_read_b64_tr_b16 v[102:103], v18 offset:4640
    ds_read_b64_tr_b16 v[104:105], v18 offset:64
    ds_read_b64_tr_b16 v[106:107], v18 offset:4672
    ds_read_b64_tr_b16 v[108:109], v18 offset:96
    ds_read_b64_tr_b16 v[110:111], v18 offset:4704
    ds_read_b64_tr_b16 v[112:113], v18 offset:128
    ds_read_b64_tr_b16 v[114:115], v18 offset:4736
    ds_read_b64_tr_b16 v[116:117], v18 offset:160
    ds_read_b64_tr_b16 v[118:119], v18 offset:4768
    ds_read_b64_tr_b16 v[120:121], v18 offset:192
    ds_read_b64_tr_b16 v[122:123], v18 offset:4800
    s_waitcnt lgkmcnt(12)
    v_mfma_f32_16x16x32_bf16 v[24:27], v[96:99], v[160:163], v[24:27]
    ds_read_b64_tr_b16 v[124:125], v18 offset:224
    v_mfma_f32_16x16x32_bf16 v[28:31], v[96:99], v[164:167], v[28:31]
    ds_read_b64_tr_b16 v[126:127], v18 offset:4832
    s_waitcnt lgkmcnt(12)
    v_mfma_f32_16x16x32_bf16 v[32:35], v[100:103], v[160:163], v[32:35]
    ds_read_b64_tr_b16 v[96:97], v18 offset:256
    v_mfma_f32_16x16x32_bf16 v[36:39], v[100:103], v[164:167], v[36:39]
    ds_read_b64_tr_b16 v[98:99], v18 offset:4864
    s_waitcnt lgkmcnt(12)
    v_mfma_f32_16x16x32_bf16 v[40:43], v[104:107], v[160:163], v[40:43]
    ds_read_b64_tr_b16 v[100:101], v18 offset:10240
    v_mfma_f32_16x16x32_bf16 v[44:47], v[104:107], v[164:167], v[44:47]
    ds_read_b64_tr_b16 v[102:103], v18 offset:14848
    s_waitcnt lgkmcnt(12)
    v_mfma_f32_16x16x32_bf16 v[48:51], v[108:111], v[160:163], v[48:51]
    ds_read_b64_tr_b16 v[104:105], v18 offset:10272
    v_mfma_f32_16x16x32_bf16 v[52:55], v[108:111], v[164:167], v[52:55]
    ds_read_b64_tr_b16 v[106:107], v18 offset:14880
    s_waitcnt lgkmcnt(12)
    v_mfma_f32_16x16x32_bf16 v[56:59], v[112:115], v[160:163], v[56:59]
    ds_read_b64_tr_b16 v[108:109], v18 offset:10304
    v_mfma_f32_16x16x32_bf16 v[60:63], v[112:115], v[164:167], v[60:63]
    ds_read_b64_tr_b16 v[110:111], v18 offset:14912
    s_waitcnt lgkmcnt(12)
    v_mfma_f32_16x16x32_bf16 v[64:67], v[116:119], v[160:163], v[64:67]
    ds_read_b64_tr_b16 v[112:113], v18 offset:10336
    v_mfma_f32_16x16x32_bf16 v[68:71], v[116:119], v[164:167], v[68:71]
    ds_read_b64_tr_b16 v[114:115], v18 offset:14944
    s_waitcnt lgkmcnt(12)
    v_mfma_f32_16x16x32_bf16 v[72:75], v[120:123], v[160:163], v[72:75]
    ds_read_b64_tr_b16 v[116:117], v18 offset:10368
    v_mfma_f32_16x16x32_bf16 v[76:79], v[120:123], v[164:167], v[76:79]
    ds_read_b64_tr_b16 v[118:119], v18 offset:14976
    s_waitcnt lgkmcnt(12)
    v_mfma_f32_16x16x32_bf16 v[80:83], v[124:127], v[160:163], v[80:83]
    ds_read_b64_tr_b16 v[120:121], v18 offset:10400
    v_mfma_f32_16x16x32_bf16 v[84:87], v[124:127], v[164:167], v[84:87]
    ds_read_b64_tr_b16 v[122:123], v18 offset:15008
    s_waitcnt lgkmcnt(12)
    v_mfma_f32_16x16x32_bf16 v[88:91], v[96:99], v[160:163], v[88:91]
    ds_read_b64_tr_b16 v[124:125], v18 offset:10432
    v_mfma_f32_16x16x32_bf16 v[92:95], v[96:99], v[164:167], v[92:95]
    ds_read_b64_tr_b16 v[126:127], v18 offset:15040
    s_waitcnt lgkmcnt(12)
    v_mfma_f32_16x16x32_bf16 v[24:27], v[100:103], v[168:171], v[24:27]
    ds_read_b64_tr_b16 v[96:97], v18 offset:10464
    v_mfma_f32_16x16x32_bf16 v[28:31], v[100:103], v[172:175], v[28:31]
    ds_read_b64_tr_b16 v[98:99], v18 offset:15072
    s_waitcnt lgkmcnt(12)
    v_mfma_f32_16x16x32_bf16 v[32:35], v[104:107], v[168:171], v[32:35]
    ds_read_b64_tr_b16 v[100:101], v18 offset:10496
    v_mfma_f32_16x16x32_bf16 v[36:39], v[104:107], v[172:175], v[36:39]
    ds_read_b64_tr_b16 v[102:103], v18 offset:15104
    s_waitcnt lgkmcnt(12)
    v_mfma_f32_16x16x32_bf16 v[40:43], v[108:111], v[168:171], v[40:43]
    ds_read_b64_tr_b16 v[104:105], v18 offset:20480
    v_mfma_f32_16x16x32_bf16 v[44:47], v[108:111], v[172:175], v[44:47]
    ds_read_b64_tr_b16 v[106:107], v18 offset:25088
    s_waitcnt lgkmcnt(12)
    v_mfma_f32_16x16x32_bf16 v[48:51], v[112:115], v[168:171], v[48:51]
    ds_read_b64_tr_b16 v[108:109], v18 offset:20512
    v_mfma_f32_16x16x32_bf16 v[52:55], v[112:115], v[172:175], v[52:55]
    ds_read_b64_tr_b16 v[110:111], v18 offset:25120
    s_waitcnt lgkmcnt(12)
    v_mfma_f32_16x16x32_bf16 v[56:59], v[116:119], v[168:171], v[56:59]
    ds_read_b64_tr_b16 v[112:113], v18 offset:20544
    v_mfma_f32_16x16x32_bf16 v[60:63], v[116:119], v[172:175], v[60:63]
    ds_read_b64_tr_b16 v[114:115], v18 offset:25152
    s_waitcnt lgkmcnt(12)
    v_mfma_f32_16x16x32_bf16 v[64:67], v[120:123], v[168:171], v[64:67]
    ds_read_b64_tr_b16 v[116:117], v18 offset:20576
    v_mfma_f32_16x16x32_bf16 v[68:71], v[120:123], v[172:175], v[68:71]
    ds_read_b64_tr_b16 v[118:119], v18 offset:25184
    s_waitcnt lgkmcnt(12)
    v_mfma_f32_16x16x32_bf16 v[72:75], v[124:127], v[168:171], v[72:75]
    ds_read_b64_tr_b16 v[120:121], v18 offset:20608
    v_mfma_f32_16x16x32_bf16 v[76:79], v[124:127], v[172:175], v[76:79]
    ds_read_b64_tr_b16 v[122:123], v18 offset:25216
    s_waitcnt lgkmcnt(12)
    v_mfma_f32_16x16x32_bf16 v[80:83], v[96:99], v[168:171], v[80:83]
    ds_read_b64_tr_b16 v[124:125], v18 offset:20640
    v_mfma_f32_16x16x32_bf16 v[84:87], v[96:99], v[172:175], v[84:87]
    ds_read_b64_tr_b16 v[126:127], v18 offset:25248
    s_waitcnt lgkmcnt(12)
    v_mfma_f32_16x16x32_bf16 v[88:91], v[100:103], v[168:171], v[88:91]
    ds_read_b64_tr_b16 v[96:97], v18 offset:20672
    v_mfma_f32_16x16x32_bf16 v[92:95], v[100:103], v[172:175], v[92:95]
    ds_read_b64_tr_b16 v[98:99], v18 offset:25280
    s_waitcnt lgkmcnt(12)
    v_mfma_f32_16x16x32_bf16 v[24:27], v[104:107], v[176:179], v[24:27]
    ds_read_b64_tr_b16 v[100:101], v18 offset:20704
    v_mfma_f32_16x16x32_bf16 v[28:31], v[104:107], v[180:183], v[28:31]
    ds_read_b64_tr_b16 v[102:103], v18 offset:25312
    s_waitcnt lgkmcnt(12)
    v_mfma_f32_16x16x32_bf16 v[32:35], v[108:111], v[176:179], v[32:35]
    ds_read_b64_tr_b16 v[104:105], v18 offset:20736
    v_mfma_f32_16x16x32_bf16 v[36:39], v[108:111], v[180:183], v[36:39]
    ds_read_b64_tr_b16 v[106:107], v18 offset:25344
    s_waitcnt lgkmcnt(12)
    v_mfma_f32_16x16x32_bf16 v[40:43], v[112:115], v[176:179], v[40:43]
    ds_read_b64_tr_b16 v[108:109], v18 offset:30720
    v_mfma_f32_16x16x32_bf16 v[44:47], v[112:115], v[180:183], v[44:47]
    ds_read_b64_tr_b16 v[110:111], v18 offset:35328
    s_waitcnt lgkmcnt(12)
    v_mfma_f32_16x16x32_bf16 v[48:51], v[116:119], v[176:179], v[48:51]
    ds_read_b64_tr_b16 v[112:113], v18 offset:30752
    v_mfma_f32_16x16x32_bf16 v[52:55], v[116:119], v[180:183], v[52:55]
    ds_read_b64_tr_b16 v[114:115], v18 offset:35360
    s_waitcnt lgkmcnt(12)
    v_mfma_f32_16x16x32_bf16 v[56:59], v[120:123], v[176:179], v[56:59]
    ds_read_b64_tr_b16 v[116:117], v18 offset:30784
    v_mfma_f32_16x16x32_bf16 v[60:63], v[120:123], v[180:183], v[60:63]
    ds_read_b64_tr_b16 v[118:119], v18 offset:35392
    s_waitcnt lgkmcnt(12)
    v_mfma_f32_16x16x32_bf16 v[64:67], v[124:127], v[176:179], v[64:67]
    ds_read_b64_tr_b16 v[120:121], v18 offset:30816
    v_mfma_f32_16x16x32_bf16 v[68:71], v[124:127], v[180:183], v[68:71]
    ds_read_b64_tr_b16 v[122:123], v18 offset:35424
    s_waitcnt lgkmcnt(12)
    v_mfma_f32_16x16x32_bf16 v[72:75], v[96:99], v[176:179], v[72:75]
    ds_read_b64_tr_b16 v[124:125], v18 offset:30848
    v_mfma_f32_16x16x32_bf16 v[76:79], v[96:99], v[180:183], v[76:79]
    ds_read_b64_tr_b16 v[126:127], v18 offset:35456
    s_waitcnt lgkmcnt(12)
    v_mfma_f32_16x16x32_bf16 v[80:83], v[100:103], v[176:179], v[80:83]
    ds_read_b64_tr_b16 v[96:97], v18 offset:30880
    v_mfma_f32_16x16x32_bf16 v[84:87], v[100:103], v[180:183], v[84:87]
    ds_read_b64_tr_b16 v[98:99], v18 offset:35488
    s_waitcnt lgkmcnt(12)
    v_mfma_f32_16x16x32_bf16 v[88:91], v[104:107], v[176:179], v[88:91]
    ds_read_b64_tr_b16 v[100:101], v18 offset:30912
    v_mfma_f32_16x16x32_bf16 v[92:95], v[104:107], v[180:183], v[92:95]
    ds_read_b64_tr_b16 v[102:103], v18 offset:35520
    s_waitcnt lgkmcnt(12)
    v_mfma_f32_16x16x32_bf16 v[24:27], v[108:111], v[184:187], v[24:27]
    ds_read_b64_tr_b16 v[104:105], v18 offset:30944
    v_mfma_f32_16x16x32_bf16 v[28:31], v[108:111], v[188:191], v[28:31]
    ds_read_b64_tr_b16 v[106:107], v18 offset:35552
    s_waitcnt lgkmcnt(12)
    v_mfma_f32_16x16x32_bf16 v[32:35], v[112:115], v[184:187], v[32:35]
    ds_read_b64_tr_b16 v[108:109], v18 offset:30976
    v_mfma_f32_16x16x32_bf16 v[36:39], v[112:115], v[188:191], v[36:39]
    ds_read_b64_tr_b16 v[110:111], v18 offset:35584
    s_waitcnt lgkmcnt(12)
    v_mfma_f32_16x16x32_bf16 v[40:43], v[116:119], v[184:187], v[40:43]
    v_mfma_f32_16x16x32_bf16 v[44:47], v[116:119], v[188:191], v[44:47]
    s_waitcnt lgkmcnt(10)
    v_mfma_f32_16x16x32_bf16 v[48:51], v[120:123], v[184:187], v[48:51]
    v_mfma_f32_16x16x32_bf16 v[52:55], v[120:123], v[188:191], v[52:55]
    s_waitcnt lgkmcnt(8)
    v_mfma_f32_16x16x32_bf16 v[56:59], v[124:127], v[184:187], v[56:59]
    v_mfma_f32_16x16x32_bf16 v[60:63], v[124:127], v[188:191], v[60:63]
    s_waitcnt lgkmcnt(6)
    v_mfma_f32_16x16x32_bf16 v[64:67], v[96:99], v[184:187], v[64:67]
    v_mfma_f32_16x16x32_bf16 v[68:71], v[96:99], v[188:191], v[68:71]
    s_waitcnt lgkmcnt(4)
    v_mfma_f32_16x16x32_bf16 v[72:75], v[100:103], v[184:187], v[72:75]
    v_mfma_f32_16x16x32_bf16 v[76:79], v[100:103], v[188:191], v[76:79]
    s_waitcnt lgkmcnt(2)
    v_mfma_f32_16x16x32_bf16 v[80:83], v[104:107], v[184:187], v[80:83]
    v_mfma_f32_16x16x32_bf16 v[84:87], v[104:107], v[188:191], v[84:87]
    s_waitcnt lgkmcnt(0)
    v_mfma_f32_16x16x32_bf16 v[88:91], v[108:111], v[184:187], v[88:91]
    v_mfma_f32_16x16x32_bf16 v[92:95], v[108:111], v[188:191], v[92:95]
    s_waitcnt vmcnt(20)
    s_barrier
    v_add_u32 v18, 81920, v17
    ds_read_b64_tr_b16 v[96:97], v18 offset:0
    ds_read_b64_tr_b16 v[98:99], v18 offset:4608
    ds_read_b64_tr_b16 v[100:101], v18 offset:32
    ds_read_b64_tr_b16 v[102:103], v18 offset:4640
    ds_read_b64_tr_b16 v[104:105], v18 offset:64
    ds_read_b64_tr_b16 v[106:107], v18 offset:4672
    ds_read_b64_tr_b16 v[108:109], v18 offset:96
    ds_read_b64_tr_b16 v[110:111], v18 offset:4704
    ds_read_b64_tr_b16 v[112:113], v18 offset:128
    ds_read_b64_tr_b16 v[114:115], v18 offset:4736
    ds_read_b64_tr_b16 v[116:117], v18 offset:160
    ds_read_b64_tr_b16 v[118:119], v18 offset:4768
    ds_read_b64_tr_b16 v[120:121], v18 offset:192
    ds_read_b64_tr_b16 v[122:123], v18 offset:4800
    s_waitcnt lgkmcnt(12)
    v_mfma_f32_16x16x32_bf16 v[24:27], v[96:99], v[192:195], v[24:27]
    ds_read_b64_tr_b16 v[124:125], v18 offset:224
    v_mfma_f32_16x16x32_bf16 v[28:31], v[96:99], v[196:199], v[28:31]
    ds_read_b64_tr_b16 v[126:127], v18 offset:4832
    s_waitcnt lgkmcnt(12)
    v_mfma_f32_16x16x32_bf16 v[32:35], v[100:103], v[192:195], v[32:35]
    ds_read_b64_tr_b16 v[96:97], v18 offset:256
    v_mfma_f32_16x16x32_bf16 v[36:39], v[100:103], v[196:199], v[36:39]
    ds_read_b64_tr_b16 v[98:99], v18 offset:4864
    s_waitcnt lgkmcnt(12)
    v_mfma_f32_16x16x32_bf16 v[40:43], v[104:107], v[192:195], v[40:43]
    ds_read_b64_tr_b16 v[100:101], v18 offset:10240
    v_mfma_f32_16x16x32_bf16 v[44:47], v[104:107], v[196:199], v[44:47]
    ds_read_b64_tr_b16 v[102:103], v18 offset:14848
    s_waitcnt lgkmcnt(12)
    v_mfma_f32_16x16x32_bf16 v[48:51], v[108:111], v[192:195], v[48:51]
    ds_read_b64_tr_b16 v[104:105], v18 offset:10272
    v_mfma_f32_16x16x32_bf16 v[52:55], v[108:111], v[196:199], v[52:55]
    ds_read_b64_tr_b16 v[106:107], v18 offset:14880
    s_waitcnt lgkmcnt(12)
    v_mfma_f32_16x16x32_bf16 v[56:59], v[112:115], v[192:195], v[56:59]
    ds_read_b64_tr_b16 v[108:109], v18 offset:10304
    v_mfma_f32_16x16x32_bf16 v[60:63], v[112:115], v[196:199], v[60:63]
    ds_read_b64_tr_b16 v[110:111], v18 offset:14912
    s_waitcnt lgkmcnt(12)
    v_mfma_f32_16x16x32_bf16 v[64:67], v[116:119], v[192:195], v[64:67]
    ds_read_b64_tr_b16 v[112:113], v18 offset:10336
    v_mfma_f32_16x16x32_bf16 v[68:71], v[116:119], v[196:199], v[68:71]
    ds_read_b64_tr_b16 v[114:115], v18 offset:14944
    s_waitcnt lgkmcnt(12)
    v_mfma_f32_16x16x32_bf16 v[72:75], v[120:123], v[192:195], v[72:75]
    ds_read_b64_tr_b16 v[116:117], v18 offset:10368
    v_mfma_f32_16x16x32_bf16 v[76:79], v[120:123], v[196:199], v[76:79]
    ds_read_b64_tr_b16 v[118:119], v18 offset:14976
    s_waitcnt lgkmcnt(12)
    v_mfma_f32_16x16x32_bf16 v[80:83], v[124:127], v[192:195], v[80:83]
    ds_read_b64_tr_b16 v[120:121], v18 offset:10400
    v_mfma_f32_16x16x32_bf16 v[84:87], v[124:127], v[196:199], v[84:87]
    ds_read_b64_tr_b16 v[122:123], v18 offset:15008
    s_waitcnt lgkmcnt(12)
    v_mfma_f32_16x16x32_bf16 v[88:91], v[96:99], v[192:195], v[88:91]
    ds_read_b64_tr_b16 v[124:125], v18 offset:10432
    v_mfma_f32_16x16x32_bf16 v[92:95], v[96:99], v[196:199], v[92:95]
    ds_read_b64_tr_b16 v[126:127], v18 offset:15040
    s_waitcnt lgkmcnt(12)
    v_mfma_f32_16x16x32_bf16 v[24:27], v[100:103], v[200:203], v[24:27]
    ds_read_b64_tr_b16 v[96:97], v18 offset:10464
    v_mfma_f32_16x16x32_bf16 v[28:31], v[100:103], v[204:207], v[28:31]
    ds_read_b64_tr_b16 v[98:99], v18 offset:15072
    s_waitcnt lgkmcnt(12)
    v_mfma_f32_16x16x32_bf16 v[32:35], v[104:107], v[200:203], v[32:35]
    ds_read_b64_tr_b16 v[100:101], v18 offset:10496
    v_mfma_f32_16x16x32_bf16 v[36:39], v[104:107], v[204:207], v[36:39]
    ds_read_b64_tr_b16 v[102:103], v18 offset:15104
    s_waitcnt lgkmcnt(12)
    v_mfma_f32_16x16x32_bf16 v[40:43], v[108:111], v[200:203], v[40:43]
    ds_read_b64_tr_b16 v[104:105], v18 offset:20480
    v_mfma_f32_16x16x32_bf16 v[44:47], v[108:111], v[204:207], v[44:47]
    ds_read_b64_tr_b16 v[106:107], v18 offset:25088
    s_waitcnt lgkmcnt(12)
    v_mfma_f32_16x16x32_bf16 v[48:51], v[112:115], v[200:203], v[48:51]
    ds_read_b64_tr_b16 v[108:109], v18 offset:20512
    v_mfma_f32_16x16x32_bf16 v[52:55], v[112:115], v[204:207], v[52:55]
    ds_read_b64_tr_b16 v[110:111], v18 offset:25120
    s_waitcnt lgkmcnt(12)
    v_mfma_f32_16x16x32_bf16 v[56:59], v[116:119], v[200:203], v[56:59]
    ds_read_b64_tr_b16 v[112:113], v18 offset:20544
    v_mfma_f32_16x16x32_bf16 v[60:63], v[116:119], v[204:207], v[60:63]
    ds_read_b64_tr_b16 v[114:115], v18 offset:25152
    s_waitcnt lgkmcnt(12)
    v_mfma_f32_16x16x32_bf16 v[64:67], v[120:123], v[200:203], v[64:67]
    ds_read_b64_tr_b16 v[116:117], v18 offset:20576
    v_mfma_f32_16x16x32_bf16 v[68:71], v[120:123], v[204:207], v[68:71]
    ds_read_b64_tr_b16 v[118:119], v18 offset:25184
    s_waitcnt lgkmcnt(12)
    v_mfma_f32_16x16x32_bf16 v[72:75], v[124:127], v[200:203], v[72:75]
    ds_read_b64_tr_b16 v[120:121], v18 offset:20608
    v_mfma_f32_16x16x32_bf16 v[76:79], v[124:127], v[204:207], v[76:79]
    ds_read_b64_tr_b16 v[122:123], v18 offset:25216
    s_waitcnt lgkmcnt(12)
    v_mfma_f32_16x16x32_bf16 v[80:83], v[96:99], v[200:203], v[80:83]
    ds_read_b64_tr_b16 v[124:125], v18 offset:20640
    v_mfma_f32_16x16x32_bf16 v[84:87], v[96:99], v[204:207], v[84:87]
    ds_read_b64_tr_b16 v[126:127], v18 offset:25248
    s_waitcnt lgkmcnt(12)
    v_mfma_f32_16x16x32_bf16 v[88:91], v[100:103], v[200:203], v[88:91]
    ds_read_b64_tr_b16 v[96:97], v18 offset:20672
    v_mfma_f32_16x16x32_bf16 v[92:95], v[100:103], v[204:207], v[92:95]
    ds_read_b64_tr_b16 v[98:99], v18 offset:25280
    s_waitcnt lgkmcnt(12)
    v_mfma_f32_16x16x32_bf16 v[24:27], v[104:107], v[208:211], v[24:27]
    ds_read_b64_tr_b16 v[100:101], v18 offset:20704
    v_mfma_f32_16x16x32_bf16 v[28:31], v[104:107], v[212:215], v[28:31]
    ds_read_b64_tr_b16 v[102:103], v18 offset:25312
    s_waitcnt lgkmcnt(12)
    v_mfma_f32_16x16x32_bf16 v[32:35], v[108:111], v[208:211], v[32:35]
    ds_read_b64_tr_b16 v[104:105], v18 offset:20736
    v_mfma_f32_16x16x32_bf16 v[36:39], v[108:111], v[212:215], v[36:39]
    ds_read_b64_tr_b16 v[106:107], v18 offset:25344
    s_waitcnt lgkmcnt(12)
    v_mfma_f32_16x16x32_bf16 v[40:43], v[112:115], v[208:211], v[40:43]
    ds_read_b64_tr_b16 v[108:109], v18 offset:30720
    v_mfma_f32_16x16x32_bf16 v[44:47], v[112:115], v[212:215], v[44:47]
    ds_read_b64_tr_b16 v[110:111], v18 offset:35328
    s_waitcnt lgkmcnt(12)
    v_mfma_f32_16x16x32_bf16 v[48:51], v[116:119], v[208:211], v[48:51]
    ds_read_b64_tr_b16 v[112:113], v18 offset:30752
    v_mfma_f32_16x16x32_bf16 v[52:55], v[116:119], v[212:215], v[52:55]
    ds_read_b64_tr_b16 v[114:115], v18 offset:35360
    s_waitcnt lgkmcnt(12)
    v_mfma_f32_16x16x32_bf16 v[56:59], v[120:123], v[208:211], v[56:59]
    ds_read_b64_tr_b16 v[116:117], v18 offset:30784
    v_mfma_f32_16x16x32_bf16 v[60:63], v[120:123], v[212:215], v[60:63]
    ds_read_b64_tr_b16 v[118:119], v18 offset:35392
    s_waitcnt lgkmcnt(12)
    v_mfma_f32_16x16x32_bf16 v[64:67], v[124:127], v[208:211], v[64:67]
    ds_read_b64_tr_b16 v[120:121], v18 offset:30816
    v_mfma_f32_16x16x32_bf16 v[68:71], v[124:127], v[212:215], v[68:71]
    ds_read_b64_tr_b16 v[122:123], v18 offset:35424
    s_waitcnt lgkmcnt(12)
    v_mfma_f32_16x16x32_bf16 v[72:75], v[96:99], v[208:211], v[72:75]
    ds_read_b64_tr_b16 v[124:125], v18 offset:30848
    v_mfma_f32_16x16x32_bf16 v[76:79], v[96:99], v[212:215], v[76:79]
    ds_read_b64_tr_b16 v[126:127], v18 offset:35456
    s_waitcnt lgkmcnt(12)
    v_mfma_f32_16x16x32_bf16 v[80:83], v[100:103], v[208:211], v[80:83]
    ds_read_b64_tr_b16 v[96:97], v18 offset:30880
    v_mfma_f32_16x16x32_bf16 v[84:87], v[100:103], v[212:215], v[84:87]
    ds_read_b64_tr_b16 v[98:99], v18 offset:35488
    s_waitcnt lgkmcnt(12)
    v_mfma_f32_16x16x32_bf16 v[88:91], v[104:107], v[208:211], v[88:91]
    ds_read_b64_tr_b16 v[100:101], v18 offset:30912
    v_mfma_f32_16x16x32_bf16 v[92:95], v[104:107], v[212:215], v[92:95]
    ds_read_b64_tr_b16 v[102:103], v18 offset:35520
    s_waitcnt lgkmcnt(12)
    v_mfma_f32_16x16x32_bf16 v[24:27], v[108:111], v[216:219], v[24:27]
    ds_read_b64_tr_b16 v[104:105], v18 offset:30944
    v_mfma_f32_16x16x32_bf16 v[28:31], v[108:111], v[220:223], v[28:31]
    ds_read_b64_tr_b16 v[106:107], v18 offset:35552
    s_waitcnt lgkmcnt(12)
    v_mfma_f32_16x16x32_bf16 v[32:35], v[112:115], v[216:219], v[32:35]
    ds_read_b64_tr_b16 v[108:109], v18 offset:30976
    v_mfma_f32_16x16x32_bf16 v[36:39], v[112:115], v[220:223], v[36:39]
    ds_read_b64_tr_b16 v[110:111], v18 offset:35584
    s_waitcnt lgkmcnt(12)
    v_mfma_f32_16x16x32_bf16 v[40:43], v[116:119], v[216:219], v[40:43]
    v_mfma_f32_16x16x32_bf16 v[44:47], v[116:119], v[220:223], v[44:47]
    s_waitcnt lgkmcnt(10)
    v_mfma_f32_16x16x32_bf16 v[48:51], v[120:123], v[216:219], v[48:51]
    v_mfma_f32_16x16x32_bf16 v[52:55], v[120:123], v[220:223], v[52:55]
    s_waitcnt lgkmcnt(8)
    v_mfma_f32_16x16x32_bf16 v[56:59], v[124:127], v[216:219], v[56:59]
    v_mfma_f32_16x16x32_bf16 v[60:63], v[124:127], v[220:223], v[60:63]
    s_waitcnt lgkmcnt(6)
    v_mfma_f32_16x16x32_bf16 v[64:67], v[96:99], v[216:219], v[64:67]
    v_mfma_f32_16x16x32_bf16 v[68:71], v[96:99], v[220:223], v[68:71]
    s_waitcnt lgkmcnt(4)
    v_mfma_f32_16x16x32_bf16 v[72:75], v[100:103], v[216:219], v[72:75]
    v_mfma_f32_16x16x32_bf16 v[76:79], v[100:103], v[220:223], v[76:79]
    s_waitcnt lgkmcnt(2)
    v_mfma_f32_16x16x32_bf16 v[80:83], v[104:107], v[216:219], v[80:83]
    v_mfma_f32_16x16x32_bf16 v[84:87], v[104:107], v[220:223], v[84:87]
    s_waitcnt lgkmcnt(0)
    v_mfma_f32_16x16x32_bf16 v[88:91], v[108:111], v[216:219], v[88:91]
    v_mfma_f32_16x16x32_bf16 v[92:95], v[108:111], v[220:223], v[92:95]
    s_waitcnt vmcnt(0)
    s_barrier
    v_add_u32 v18, 122880, v17
    ds_read_b64_tr_b16 v[96:97], v18 offset:0
    ds_read_b64_tr_b16 v[98:99], v18 offset:4608
    ds_read_b64_tr_b16 v[100:101], v18 offset:32
    ds_read_b64_tr_b16 v[102:103], v18 offset:4640
    ds_read_b64_tr_b16 v[104:105], v18 offset:64
    ds_read_b64_tr_b16 v[106:107], v18 offset:4672
    ds_read_b64_tr_b16 v[108:109], v18 offset:96
    ds_read_b64_tr_b16 v[110:111], v18 offset:4704
    ds_read_b64_tr_b16 v[112:113], v18 offset:128
    ds_read_b64_tr_b16 v[114:115], v18 offset:4736
    ds_read_b64_tr_b16 v[116:117], v18 offset:160
    ds_read_b64_tr_b16 v[118:119], v18 offset:4768
    ds_read_b64_tr_b16 v[120:121], v18 offset:192
    ds_read_b64_tr_b16 v[122:123], v18 offset:4800
    s_waitcnt lgkmcnt(12)
    v_mfma_f32_16x16x32_bf16 v[24:27], v[96:99], v[224:227], v[24:27]
    ds_read_b64_tr_b16 v[124:125], v18 offset:224
    v_mfma_f32_16x16x32_bf16 v[28:31], v[96:99], v[228:231], v[28:31]
    ds_read_b64_tr_b16 v[126:127], v18 offset:4832
    s_waitcnt lgkmcnt(12)
    v_mfma_f32_16x16x32_bf16 v[32:35], v[100:103], v[224:227], v[32:35]
    ds_read_b64_tr_b16 v[96:97], v18 offset:256
    v_mfma_f32_16x16x32_bf16 v[36:39], v[100:103], v[228:231], v[36:39]
    ds_read_b64_tr_b16 v[98:99], v18 offset:4864
    s_waitcnt lgkmcnt(12)
    v_mfma_f32_16x16x32_bf16 v[40:43], v[104:107], v[224:227], v[40:43]
    ds_read_b64_tr_b16 v[100:101], v18 offset:10240
    v_mfma_f32_16x16x32_bf16 v[44:47], v[104:107], v[228:231], v[44:47]
    ds_read_b64_tr_b16 v[102:103], v18 offset:14848
    s_waitcnt lgkmcnt(12)
    v_mfma_f32_16x16x32_bf16 v[48:51], v[108:111], v[224:227], v[48:51]
    ds_read_b64_tr_b16 v[104:105], v18 offset:10272
    v_mfma_f32_16x16x32_bf16 v[52:55], v[108:111], v[228:231], v[52:55]
    ds_read_b64_tr_b16 v[106:107], v18 offset:14880
    s_waitcnt lgkmcnt(12)
    v_mfma_f32_16x16x32_bf16 v[56:59], v[112:115], v[224:227], v[56:59]
    ds_read_b64_tr_b16 v[108:109], v18 offset:10304
    v_mfma_f32_16x16x32_bf16 v[60:63], v[112:115], v[228:231], v[60:63]
    ds_read_b64_tr_b16 v[110:111], v18 offset:14912
    s_waitcnt lgkmcnt(12)
    v_mfma_f32_16x16x32_bf16 v[64:67], v[116:119], v[224:227], v[64:67]
    ds_read_b64_tr_b16 v[112:113], v18 offset:10336
    v_mfma_f32_16x16x32_bf16 v[68:71], v[116:119], v[228:231], v[68:71]
    ds_read_b64_tr_b16 v[114:115], v18 offset:14944
    s_waitcnt lgkmcnt(12)
    v_mfma_f32_16x16x32_bf16 v[72:75], v[120:123], v[224:227], v[72:75]
    ds_read_b64_tr_b16 v[116:117], v18 offset:10368
    v_mfma_f32_16x16x32_bf16 v[76:79], v[120:123], v[228:231], v[76:79]
    ds_read_b64_tr_b16 v[118:119], v18 offset:14976
    s_waitcnt lgkmcnt(12)
    v_mfma_f32_16x16x32_bf16 v[80:83], v[124:127], v[224:227], v[80:83]
    ds_read_b64_tr_b16 v[120:121], v18 offset:10400
    v_mfma_f32_16x16x32_bf16 v[84:87], v[124:127], v[228:231], v[84:87]
    ds_read_b64_tr_b16 v[122:123], v18 offset:15008
    s_waitcnt lgkmcnt(12)
    v_mfma_f32_16x16x32_bf16 v[88:91], v[96:99], v[224:227], v[88:91]
    ds_read_b64_tr_b16 v[124:125], v18 offset:10432
    v_mfma_f32_16x16x32_bf16 v[92:95], v[96:99], v[228:231], v[92:95]
    ds_read_b64_tr_b16 v[126:127], v18 offset:15040
    s_waitcnt lgkmcnt(12)
    v_mfma_f32_16x16x32_bf16 v[24:27], v[100:103], v[232:235], v[24:27]
    ds_read_b64_tr_b16 v[96:97], v18 offset:10464
    v_mfma_f32_16x16x32_bf16 v[28:31], v[100:103], v[236:239], v[28:31]
    ds_read_b64_tr_b16 v[98:99], v18 offset:15072
    s_waitcnt lgkmcnt(12)
    v_mfma_f32_16x16x32_bf16 v[32:35], v[104:107], v[232:235], v[32:35]
    ds_read_b64_tr_b16 v[100:101], v18 offset:10496
    v_mfma_f32_16x16x32_bf16 v[36:39], v[104:107], v[236:239], v[36:39]
    ds_read_b64_tr_b16 v[102:103], v18 offset:15104
    s_waitcnt lgkmcnt(12)
    v_mfma_f32_16x16x32_bf16 v[40:43], v[108:111], v[232:235], v[40:43]
    ds_read_b64_tr_b16 v[104:105], v18 offset:20480
    v_mfma_f32_16x16x32_bf16 v[44:47], v[108:111], v[236:239], v[44:47]
    ds_read_b64_tr_b16 v[106:107], v18 offset:25088
    s_waitcnt lgkmcnt(12)
    v_mfma_f32_16x16x32_bf16 v[48:51], v[112:115], v[232:235], v[48:51]
    ds_read_b64_tr_b16 v[108:109], v18 offset:20512
    v_mfma_f32_16x16x32_bf16 v[52:55], v[112:115], v[236:239], v[52:55]
    ds_read_b64_tr_b16 v[110:111], v18 offset:25120
    s_waitcnt lgkmcnt(12)
    v_mfma_f32_16x16x32_bf16 v[56:59], v[116:119], v[232:235], v[56:59]
    ds_read_b64_tr_b16 v[112:113], v18 offset:20544
    v_mfma_f32_16x16x32_bf16 v[60:63], v[116:119], v[236:239], v[60:63]
    ds_read_b64_tr_b16 v[114:115], v18 offset:25152
    s_waitcnt lgkmcnt(12)
    v_mfma_f32_16x16x32_bf16 v[64:67], v[120:123], v[232:235], v[64:67]
    ds_read_b64_tr_b16 v[116:117], v18 offset:20576
    v_mfma_f32_16x16x32_bf16 v[68:71], v[120:123], v[236:239], v[68:71]
    ds_read_b64_tr_b16 v[118:119], v18 offset:25184
    s_waitcnt lgkmcnt(12)
    v_mfma_f32_16x16x32_bf16 v[72:75], v[124:127], v[232:235], v[72:75]
    ds_read_b64_tr_b16 v[120:121], v18 offset:20608
    v_mfma_f32_16x16x32_bf16 v[76:79], v[124:127], v[236:239], v[76:79]
    ds_read_b64_tr_b16 v[122:123], v18 offset:25216
    s_waitcnt lgkmcnt(12)
    v_mfma_f32_16x16x32_bf16 v[80:83], v[96:99], v[232:235], v[80:83]
    ds_read_b64_tr_b16 v[124:125], v18 offset:20640
    v_mfma_f32_16x16x32_bf16 v[84:87], v[96:99], v[236:239], v[84:87]
    ds_read_b64_tr_b16 v[126:127], v18 offset:25248
    s_waitcnt lgkmcnt(12)
    v_mfma_f32_16x16x32_bf16 v[88:91], v[100:103], v[232:235], v[88:91]
    ds_read_b64_tr_b16 v[96:97], v18 offset:20672
    v_mfma_f32_16x16x32_bf16 v[92:95], v[100:103], v[236:239], v[92:95]
    ds_read_b64_tr_b16 v[98:99], v18 offset:25280
    s_waitcnt lgkmcnt(12)
    v_mfma_f32_16x16x32_bf16 v[24:27], v[104:107], v[240:243], v[24:27]
    ds_read_b64_tr_b16 v[100:101], v18 offset:20704
    v_mfma_f32_16x16x32_bf16 v[28:31], v[104:107], v[244:247], v[28:31]
    ds_read_b64_tr_b16 v[102:103], v18 offset:25312
    s_waitcnt lgkmcnt(12)
    v_mfma_f32_16x16x32_bf16 v[32:35], v[108:111], v[240:243], v[32:35]
    ds_read_b64_tr_b16 v[104:105], v18 offset:20736
    v_mfma_f32_16x16x32_bf16 v[36:39], v[108:111], v[244:247], v[36:39]
    ds_read_b64_tr_b16 v[106:107], v18 offset:25344
    s_waitcnt lgkmcnt(12)
    v_mfma_f32_16x16x32_bf16 v[40:43], v[112:115], v[240:243], v[40:43]
    ds_read_b64_tr_b16 v[108:109], v18 offset:30720
    v_mfma_f32_16x16x32_bf16 v[44:47], v[112:115], v[244:247], v[44:47]
    ds_read_b64_tr_b16 v[110:111], v18 offset:35328
    s_waitcnt lgkmcnt(12)
    v_mfma_f32_16x16x32_bf16 v[48:51], v[116:119], v[240:243], v[48:51]
    ds_read_b64_tr_b16 v[112:113], v18 offset:30752
    v_mfma_f32_16x16x32_bf16 v[52:55], v[116:119], v[244:247], v[52:55]
    ds_read_b64_tr_b16 v[114:115], v18 offset:35360
    s_waitcnt lgkmcnt(12)
    v_mfma_f32_16x16x32_bf16 v[56:59], v[120:123], v[240:243], v[56:59]
    ds_read_b64_tr_b16 v[116:117], v18 offset:30784
    v_mfma_f32_16x16x32_bf16 v[60:63], v[120:123], v[244:247], v[60:63]
    ds_read_b64_tr_b16 v[118:119], v18 offset:35392
    s_waitcnt lgkmcnt(12)
    v_mfma_f32_16x16x32_bf16 v[64:67], v[124:127], v[240:243], v[64:67]
    ds_read_b64_tr_b16 v[120:121], v18 offset:30816
    v_mfma_f32_16x16x32_bf16 v[68:71], v[124:127], v[244:247], v[68:71]
    ds_read_b64_tr_b16 v[122:123], v18 offset:35424
    s_waitcnt lgkmcnt(12)
    v_mfma_f32_16x16x32_bf16 v[72:75], v[96:99], v[240:243], v[72:75]
    ds_read_b64_tr_b16 v[124:125], v18 offset:30848
    v_mfma_f32_16x16x32_bf16 v[76:79], v[96:99], v[244:247], v[76:79]
    ds_read_b64_tr_b16 v[126:127], v18 offset:35456
    s_waitcnt lgkmcnt(12)
    v_mfma_f32_16x16x32_bf16 v[80:83], v[100:103], v[240:243], v[80:83]
    ds_read_b64_tr_b16 v[96:97], v18 offset:30880
    v_mfma_f32_16x16x32_bf16 v[84:87], v[100:103], v[244:247], v[84:87]
    ds_read_b64_tr_b16 v[98:99], v18 offset:35488
    s_waitcnt lgkmcnt(12)
    v_mfma_f32_16x16x32_bf16 v[88:91], v[104:107], v[240:243], v[88:91]
    ds_read_b64_tr_b16 v[100:101], v18 offset:30912
    v_mfma_f32_16x16x32_bf16 v[92:95], v[104:107], v[244:247], v[92:95]
    ds_read_b64_tr_b16 v[102:103], v18 offset:35520
    s_waitcnt lgkmcnt(12)
    v_mfma_f32_16x16x32_bf16 v[24:27], v[108:111], v[248:251], v[24:27]
    ds_read_b64_tr_b16 v[104:105], v18 offset:30944
    v_mfma_f32_16x16x32_bf16 v[28:31], v[108:111], v[252:255], v[28:31]
    ds_read_b64_tr_b16 v[106:107], v18 offset:35552
    s_waitcnt lgkmcnt(12)
    v_mfma_f32_16x16x32_bf16 v[32:35], v[112:115], v[248:251], v[32:35]
    ds_read_b64_tr_b16 v[108:109], v18 offset:30976
    v_mfma_f32_16x16x32_bf16 v[36:39], v[112:115], v[252:255], v[36:39]
    ds_read_b64_tr_b16 v[110:111], v18 offset:35584
    s_waitcnt lgkmcnt(12)
    v_mfma_f32_16x16x32_bf16 v[40:43], v[116:119], v[248:251], v[40:43]
    v_mfma_f32_16x16x32_bf16 v[44:47], v[116:119], v[252:255], v[44:47]
    s_waitcnt lgkmcnt(10)
    v_mfma_f32_16x16x32_bf16 v[48:51], v[120:123], v[248:251], v[48:51]
    v_mfma_f32_16x16x32_bf16 v[52:55], v[120:123], v[252:255], v[52:55]
    s_waitcnt lgkmcnt(8)
    v_mfma_f32_16x16x32_bf16 v[56:59], v[124:127], v[248:251], v[56:59]
    v_mfma_f32_16x16x32_bf16 v[60:63], v[124:127], v[252:255], v[60:63]
    s_waitcnt lgkmcnt(6)
    v_mfma_f32_16x16x32_bf16 v[64:67], v[96:99], v[248:251], v[64:67]
    v_mfma_f32_16x16x32_bf16 v[68:71], v[96:99], v[252:255], v[68:71]
    s_waitcnt lgkmcnt(4)
    v_mfma_f32_16x16x32_bf16 v[72:75], v[100:103], v[248:251], v[72:75]
    v_mfma_f32_16x16x32_bf16 v[76:79], v[100:103], v[252:255], v[76:79]
    s_waitcnt lgkmcnt(2)
    v_mfma_f32_16x16x32_bf16 v[80:83], v[104:107], v[248:251], v[80:83]
    v_mfma_f32_16x16x32_bf16 v[84:87], v[104:107], v[252:255], v[84:87]
    s_waitcnt lgkmcnt(0)
    v_mfma_f32_16x16x32_bf16 v[88:91], v[108:111], v[248:251], v[88:91]
    v_mfma_f32_16x16x32_bf16 v[92:95], v[108:111], v[252:255], v[92:95]
    s_mul_i32 s3, s32, 18432
    v_lshlrev_b32 v2, 4, v1
    v_add_u32 v19, s3, v2
    s_bfe_u32 s3, s47, 0x80000
    v_mov_b32 v6, s3
    s_bfe_u32 s3, s47, 0x80008
    v_mov_b32 v7, s3
    s_bfe_u32 s3, s47, 0x80010
    v_mov_b32 v8, s3
    s_bfe_u32 s3, s47, 0x80018
    v_mov_b32 v9, s3
    s_movk_i32 s5, 0xff
    v_and_b32 v3, 15, v1
    v_mul_u32_u24 v3, 2304, v3
    v_lshrrev_b32 v4, 4, v1
    v_lshl_add_u32 v3, v4, 3, v3
    v_add_u32 v4, 36864, v3
    s_mov_b32 s45, 0
    s_cmp_eq_u32 s29, 1
    s_cbranch_scc1 L_op_red1
    s_cmp_eq_u32 s29, 2
    s_cbranch_scc1 L_op_red2
    s_cmp_eq_u32 s29, 3
    s_cbranch_scc1 L_op_red3
L_op_red0:
    v_bfi_b32 v28, s5, v6, v28
    v_bfi_b32 v29, s5, v7, v29
    v_bfi_b32 v30, s5, v8, v30
    v_bfi_b32 v31, s5, v9, v31
    s_mov_b32 s3, 1024
    buffer_store_dwordx4 v[28:31], v19, s[16:19], s3 offen sc1
    v_bfi_b32 v32, s5, v6, v32
    v_bfi_b32 v33, s5, v7, v33
    v_bfi_b32 v34, s5, v8, v34
    v_bfi_b32 v35, s5, v9, v35
    s_mov_b32 s3, 2048
    buffer_store_dwordx4 v[32:35], v19, s[16:19], s3 offen sc1
    v_bfi_b32 v36, s5, v6, v36
    v_bfi_b32 v37, s5, v7, v37
    v_bfi_b32 v38, s5, v8, v38
    v_bfi_b32 v39, s5, v9, v39
    s_mov_b32 s3, 3072
    buffer_store_dwordx4 v[36:39], v19, s[16:19], s3 offen sc1
    v_bfi_b32 v44, s5, v6, v44
    v_bfi_b32 v45, s5, v7, v45
    v_bfi_b32 v46, s5, v8, v46
    v_bfi_b32 v47, s5, v9, v47
    s_mov_b32 s3, 5120
    buffer_store_dwordx4 v[44:47], v19, s[16:19], s3 offen sc1
    v_bfi_b32 v48, s5, v6, v48
    v_bfi_b32 v49, s5, v7, v49
    v_bfi_b32 v50, s5, v8, v50
    v_bfi_b32 v51, s5, v9, v51
    s_mov_b32 s3, 6144
    buffer_store_dwordx4 v[48:51], v19, s[16:19], s3 offen sc1
    v_bfi_b32 v52, s5, v6, v52
    v_bfi_b32 v53, s5, v7, v53
    v_bfi_b32 v54, s5, v8, v54
    v_bfi_b32 v55, s5, v9, v55
    s_mov_b32 s3, 7168
    buffer_store_dwordx4 v[52:55], v19, s[16:19], s3 offen sc1
    v_bfi_b32 v60, s5, v6, v60
    v_bfi_b32 v61, s5, v7, v61
    v_bfi_b32 v62, s5, v8, v62
    v_bfi_b32 v63, s5, v9, v63
    s_mov_b32 s3, 9216
    buffer_store_dwordx4 v[60:63], v19, s[16:19], s3 offen sc1
    v_bfi_b32 v64, s5, v6, v64
    v_bfi_b32 v65, s5, v7, v65
    v_bfi_b32 v66, s5, v8, v66
    v_bfi_b32 v67, s5, v9, v67
    s_mov_b32 s3, 10240
    buffer_store_dwordx4 v[64:67], v19, s[16:19], s3 offen sc1
    v_bfi_b32 v68, s5, v6, v68
    v_bfi_b32 v69, s5, v7, v69
    v_bfi_b32 v70, s5, v8, v70
    v_bfi_b32 v71, s5, v9, v71
    s_mov_b32 s3, 11264
    buffer_store_dwordx4 v[68:71], v19, s[16:19], s3 offen sc1
    v_bfi_b32 v76, s5, v6, v76
    v_bfi_b32 v77, s5, v7, v77
    v_bfi_b32 v78, s5, v8, v78
    v_bfi_b32 v79, s5, v9, v79
    s_mov_b32 s3, 13312
    buffer_store_dwordx4 v[76:79], v19, s[16:19], s3 offen sc1
    v_bfi_b32 v80, s5, v6, v80
    v_bfi_b32 v81, s5, v7, v81
    v_bfi_b32 v82, s5, v8, v82
    v_bfi_b32 v83, s5, v9, v83
    s_mov_b32 s3, 14336
    buffer_store_dwordx4 v[80:83], v19, s[16:19], s3 offen sc1
    v_bfi_b32 v84, s5, v6, v84
    v_bfi_b32 v85, s5, v7, v85
    v_bfi_b32 v86, s5, v8, v86
    v_bfi_b32 v87, s5, v9, v87
    s_mov_b32 s3, 15360
    buffer_store_dwordx4 v[84:87], v19, s[16:19], s3 offen sc1
    v_bfi_b32 v92, s5, v6, v92
    v_bfi_b32 v93, s5, v7, v93
    v_bfi_b32 v94, s5, v8, v94
    v_bfi_b32 v95, s5, v9, v95
    s_mov_b32 s3, 17408
    buffer_store_dwordx4 v[92:95], v19, s[16:19], s3 offen sc1
L_op_retry0:
    s_mov_b32 s3, 73728
    buffer_load_dwordx4 v[96:99], v19, s[16:19], s3 offen sc1
    s_mov_b32 s3, 77824
    buffer_load_dwordx4 v[100:103], v19, s[16:19], s3 offen sc1
    s_mov_b32 s3, 81920
    buffer_load_dwordx4 v[104:107], v19, s[16:19], s3 offen sc1
    s_mov_b32 s3, 86016
    buffer_load_dwordx4 v[108:111], v19, s[16:19], s3 offen sc1
    s_mov_b32 s3, 90112
    buffer_load_dwordx4 v[112:115], v19, s[16:19], s3 offen sc1
    s_mov_b32 s3, 147456
    buffer_load_dwordx4 v[116:119], v19, s[16:19], s3 offen sc1
    s_mov_b32 s3, 151552
    buffer_load_dwordx4 v[120:123], v19, s[16:19], s3 offen sc1
    s_mov_b32 s3, 155648
    buffer_load_dwordx4 v[124:127], v19, s[16:19], s3 offen sc1
    s_mov_b32 s3, 159744
    buffer_load_dwordx4 v[128:131], v19, s[16:19], s3 offen sc1
    s_mov_b32 s3, 163840
    buffer_load_dwordx4 v[132:135], v19, s[16:19], s3 offen sc1
    s_mov_b32 s3, 221184
    buffer_load_dwordx4 v[136:139], v19, s[16:19], s3 offen sc1
    s_mov_b32 s3, 225280
    buffer_load_dwordx4 v[140:143], v19, s[16:19], s3 offen sc1
    s_mov_b32 s3, 229376
    buffer_load_dwordx4 v[144:147], v19, s[16:19], s3 offen sc1
    s_mov_b32 s3, 233472
    buffer_load_dwordx4 v[148:151], v19, s[16:19], s3 offen sc1
    s_mov_b32 s3, 237568
    buffer_load_dwordx4 v[152:155], v19, s[16:19], s3 offen sc1
    v_mov_b32 v10, 0
    s_add_u32 s45, s45, 1
    s_waitcnt vmcnt(0)
    v_xor_b32 v5, v96, v6
    v_and_or_b32 v10, v5, s5, v10
    v_xor_b32 v5, v97, v7
    v_and_or_b32 v10, v5, s5, v10
    v_xor_b32 v5, v98, v8
    v_and_or_b32 v10, v5, s5, v10
    v_xor_b32 v5, v99, v9
    v_and_or_b32 v10, v5, s5, v10
    v_xor_b32 v5, v100, v6
    v_and_or_b32 v10, v5, s5, v10
    v_xor_b32 v5, v101, v7
    v_and_or_b32 v10, v5, s5, v10
    v_xor_b32 v5, v102, v8
    v_and_or_b32 v10, v5, s5, v10
    v_xor_b32 v5, v103, v9
    v_and_or_b32 v10, v5, s5, v10
    v_xor_b32 v5, v104, v6
    v_and_or_b32 v10, v5, s5, v10
    v_xor_b32 v5, v105, v7
    v_and_or_b32 v10, v5, s5, v10
    v_xor_b32 v5, v106, v8
    v_and_or_b32 v10, v5, s5, v10
    v_xor_b32 v5, v107, v9
    v_and_or_b32 v10, v5, s5, v10
    v_xor_b32 v5, v108, v6
    v_and_or_b32 v10, v5, s5, v10
    v_xor_b32 v5, v109, v7
    v_and_or_b32 v10, v5, s5, v10
    v_xor_b32 v5, v110, v8
    v_and_or_b32 v10, v5, s5, v10
    v_xor_b32 v5, v111, v9
    v_and_or_b32 v10, v5, s5, v10
    v_xor_b32 v5, v112, v6
    v_and_or_b32 v10, v5, s5, v10
    v_xor_b32 v5, v113, v7
    v_and_or_b32 v10, v5, s5, v10
    v_xor_b32 v5, v114, v8
    v_and_or_b32 v10, v5, s5, v10
    v_xor_b32 v5, v115, v9
    v_and_or_b32 v10, v5, s5, v10
    v_xor_b32 v5, v116, v6
    v_and_or_b32 v10, v5, s5, v10
    v_xor_b32 v5, v117, v7
    v_and_or_b32 v10, v5, s5, v10
    v_xor_b32 v5, v118, v8
    v_and_or_b32 v10, v5, s5, v10
    v_xor_b32 v5, v119, v9
    v_and_or_b32 v10, v5, s5, v10
    v_xor_b32 v5, v120, v6
    v_and_or_b32 v10, v5, s5, v10
    v_xor_b32 v5, v121, v7
    v_and_or_b32 v10, v5, s5, v10
    v_xor_b32 v5, v122, v8
    v_and_or_b32 v10, v5, s5, v10
    v_xor_b32 v5, v123, v9
    v_and_or_b32 v10, v5, s5, v10
    v_xor_b32 v5, v124, v6
    v_and_or_b32 v10, v5, s5, v10
    v_xor_b32 v5, v125, v7
    v_and_or_b32 v10, v5, s5, v10
    v_xor_b32 v5, v126, v8
    v_and_or_b32 v10, v5, s5, v10
    v_xor_b32 v5, v127, v9
    v_and_or_b32 v10, v5, s5, v10
    v_xor_b32 v5, v128, v6
    v_and_or_b32 v10, v5, s5, v10
    v_xor_b32 v5, v129, v7
    v_and_or_b32 v10, v5, s5, v10
    v_xor_b32 v5, v130, v8
    v_and_or_b32 v10, v5, s5, v10
    v_xor_b32 v5, v131, v9
    v_and_or_b32 v10, v5, s5, v10
    v_xor_b32 v5, v132, v6
    v_and_or_b32 v10, v5, s5, v10
    v_xor_b32 v5, v133, v7
    v_and_or_b32 v10, v5, s5, v10
    v_xor_b32 v5, v134, v8
    v_and_or_b32 v10, v5, s5, v10
    v_xor_b32 v5, v135, v9
    v_and_or_b32 v10, v5, s5, v10
    v_xor_b32 v5, v136, v6
    v_and_or_b32 v10, v5, s5, v10
    v_xor_b32 v5, v137, v7
    v_and_or_b32 v10, v5, s5, v10
    v_xor_b32 v5, v138, v8
    v_and_or_b32 v10, v5, s5, v10
    v_xor_b32 v5, v139, v9
    v_and_or_b32 v10, v5, s5, v10
    v_xor_b32 v5, v140, v6
    v_and_or_b32 v10, v5, s5, v10
    v_xor_b32 v5, v141, v7
    v_and_or_b32 v10, v5, s5, v10
    v_xor_b32 v5, v142, v8
    v_and_or_b32 v10, v5, s5, v10
    v_xor_b32 v5, v143, v9
    v_and_or_b32 v10, v5, s5, v10
    v_xor_b32 v5, v144, v6
    v_and_or_b32 v10, v5, s5, v10
    v_xor_b32 v5, v145, v7
    v_and_or_b32 v10, v5, s5, v10
    v_xor_b32 v5, v146, v8
    v_and_or_b32 v10, v5, s5, v10
    v_xor_b32 v5, v147, v9
    v_and_or_b32 v10, v5, s5, v10
    v_xor_b32 v5, v148, v6
    v_and_or_b32 v10, v5, s5, v10
    v_xor_b32 v5, v149, v7
    v_and_or_b32 v10, v5, s5, v10
    v_xor_b32 v5, v150, v8
    v_and_or_b32 v10, v5, s5, v10
    v_xor_b32 v5, v151, v9
    v_and_or_b32 v10, v5, s5, v10
    v_xor_b32 v5, v152, v6
    v_and_or_b32 v10, v5, s5, v10
    v_xor_b32 v5, v153, v7
    v_and_or_b32 v10, v5, s5, v10
    v_xor_b32 v5, v154, v8
    v_and_or_b32 v10, v5, s5, v10
    v_xor_b32 v5, v155, v9
    v_and_or_b32 v10, v5, s5, v10
    v_cmp_ne_u32 vcc, 0, v10
    s_cbranch_vccz L_op_ok0
    s_cmp_lt_u32 s45, 0x20000
    s_cbranch_scc1 L_op_retry0
L_op_ok0:
    v_add_f32 v24, v24, v96
    v_add_f32 v25, v25, v97
    v_add_f32 v26, v26, v98
    v_add_f32 v27, v27, v99
    v_add_f32 v40, v40, v100
    v_add_f32 v41, v41, v101
    v_add_f32 v42, v42, v102
    v_add_f32 v43, v43, v103
    v_add_f32 v56, v56, v104
    v_add_f32 v57, v57, v105
    v_add_f32 v58, v58, v106
    v_add_f32 v59, v59, v107
    v_add_f32 v72, v72, v108
    v_add_f32 v73, v73, v109
    v_add_f32 v74, v74, v110
    v_add_f32 v75, v75, v111
    v_add_f32 v88, v88, v112
    v_add_f32 v89, v89, v113
    v_add_f32 v90, v90, v114
    v_add_f32 v91, v91, v115
    v_add_f32 v24, v24, v116
    v_add_f32 v25, v25, v117
    v_add_f32 v26, v26, v118
    v_add_f32 v27, v27, v119
    v_add_f32 v40, v40, v120
    v_add_f32 v41, v41, v121
    v_add_f32 v42, v42, v122
    v_add_f32 v43, v43, v123
    v_add_f32 v56, v56, v124
    v_add_f32 v57, v57, v125
    v_add_f32 v58, v58, v126
    v_add_f32 v59, v59, v127
    v_add_f32 v72, v72, v128
    v_add_f32 v73, v73, v129
    v_add_f32 v74, v74, v130
    v_add_f32 v75, v75, v131
    v_add_f32 v88, v88, v132
    v_add_f32 v89, v89, v133
    v_add_f32 v90, v90, v134
    v_add_f32 v91, v91, v135
    v_add_f32 v24, v24, v136
    v_add_f32 v25, v25, v137
    v_add_f32 v26, v26, v138
    v_add_f32 v27, v27, v139
    v_add_f32 v40, v40, v140
    v_add_f32 v41, v41, v141
    v_add_f32 v42, v42, v142
    v_add_f32 v43, v43, v143
    v_add_f32 v56, v56, v144
    v_add_f32 v57, v57, v145
    v_add_f32 v58, v58, v146
    v_add_f32 v59, v59, v147
    v_add_f32 v72, v72, v148
    v_add_f32 v73, v73, v149
    v_add_f32 v74, v74, v150
    v_add_f32 v75, v75, v151
    v_add_f32 v88, v88, v152
    v_add_f32 v89, v89, v153
    v_add_f32 v90, v90, v154
    v_add_f32 v91, v91, v155
    v_cvt_pk_bf16_f32 v24, v24, v25
    v_cvt_pk_bf16_f32 v25, v26, v27
    buffer_store_dwordx2 v[24:25], v3, s[24:27], 0 offen offset:0
    v_cvt_pk_bf16_f32 v40, v40, v41
    v_cvt_pk_bf16_f32 v41, v42, v43
    buffer_store_dwordx2 v[40:41], v3, s[24:27], 0 offen offset:64
    v_cvt_pk_bf16_f32 v56, v56, v57
    v_cvt_pk_bf16_f32 v57, v58, v59
    buffer_store_dwordx2 v[56:57], v3, s[24:27], 0 offen offset:128
    v_cvt_pk_bf16_f32 v72, v72, v73
    v_cvt_pk_bf16_f32 v73, v74, v75
    buffer_store_dwordx2 v[72:73], v3, s[24:27], 0 offen offset:192
    v_cvt_pk_bf16_f32 v88, v88, v89
    v_cvt_pk_bf16_f32 v89, v90, v91
    buffer_store_dwordx2 v[88:89], v3, s[24:27], 0 offen offset:256
    s_branch L_op_fin
L_op_red1:
    v_bfi_b32 v24, s5, v6, v24
    v_bfi_b32 v25, s5, v7, v25
    v_bfi_b32 v26, s5, v8, v26
    v_bfi_b32 v27, s5, v9, v27
    s_mov_b32 s3, 73728
    buffer_store_dwordx4 v[24:27], v19, s[16:19], s3 offen sc1
    v_bfi_b32 v32, s5, v6, v32
    v_bfi_b32 v33, s5, v7, v33
    v_bfi_b32 v34, s5, v8, v34
    v_bfi_b32 v35, s5, v9, v35
    s_mov_b32 s3, 75776
    buffer_store_dwordx4 v[32:35], v19, s[16:19], s3 offen sc1
    v_bfi_b32 v36, s5, v6, v36
    v_bfi_b32 v37, s5, v7, v37
    v_bfi_b32 v38, s5, v8, v38
    v_bfi_b32 v39, s5, v9, v39
    s_mov_b32 s3, 76800
    buffer_store_dwordx4 v[36:39], v19, s[16:19], s3 offen sc1
    v_bfi_b32 v40, s5, v6, v40
    v_bfi_b32 v41, s5, v7, v41
    v_bfi_b32 v42, s5, v8, v42
    v_bfi_b32 v43, s5, v9, v43
    s_mov_b32 s3, 77824
    buffer_store_dwordx4 v[40:43], v19, s[16:19], s3 offen sc1
    v_bfi_b32 v48, s5, v6, v48
    v_bfi_b32 v49, s5, v7, v49
    v_bfi_b32 v50, s5, v8, v50
    v_bfi_b32 v51, s5, v9, v51
    s_mov_b32 s3, 79872
    buffer_store_dwordx4 v[48:51], v19, s[16:19], s3 offen sc1
    v_bfi_b32 v52, s5, v6, v52
    v_bfi_b32 v53, s5, v7, v53
    v_bfi_b32 v54, s5, v8, v54
    v_bfi_b32 v55, s5, v9, v55
    s_mov_b32 s3, 80896
    buffer_store_dwordx4 v[52:55], v19, s[16:19], s3 offen sc1
    v_bfi_b32 v56, s5, v6, v56
    v_bfi_b32 v57, s5, v7, v57
    v_bfi_b32 v58, s5, v8, v58
    v_bfi_b32 v59, s5, v9, v59
    s_mov_b32 s3, 81920
    buffer_store_dwordx4 v[56:59], v19, s[16:19], s3 offen sc1
    v_bfi_b32 v64, s5, v6, v64
    v_bfi_b32 v65, s5, v7, v65
    v_bfi_b32 v66, s5, v8, v66
    v_bfi_b32 v67, s5, v9, v67
    s_mov_b32 s3, 83968
    buffer_store_dwordx4 v[64:67], v19, s[16:19], s3 offen sc1
    v_bfi_b32 v68, s5, v6, v68
    v_bfi_b32 v69, s5, v7, v69
    v_bfi_b32 v70, s5, v8, v70
    v_bfi_b32 v71, s5, v9, v71
    s_mov_b32 s3, 84992
    buffer_store_dwordx4 v[68:71], v19, s[16:19], s3 offen sc1
    v_bfi_b32 v72, s5, v6, v72
    v_bfi_b32 v73, s5, v7, v73
    v_bfi_b32 v74, s5, v8, v74
    v_bfi_b32 v75, s5, v9, v75
    s_mov_b32 s3, 86016
    buffer_store_dwordx4 v[72:75], v19, s[16:19], s3 offen sc1
    v_bfi_b32 v80, s5, v6, v80
    v_bfi_b32 v81, s5, v7, v81
    v_bfi_b32 v82, s5, v8, v82
    v_bfi_b32 v83, s5, v9, v83
    s_mov_b32 s3, 88064
    buffer_store_dwordx4 v[80:83], v19, s[16:19], s3 offen sc1
    v_bfi_b32 v84, s5, v6, v84
    v_bfi_b32 v85, s5, v7, v85
    v_bfi_b32 v86, s5, v8, v86
    v_bfi_b32 v87, s5, v9, v87
    s_mov_b32 s3, 89088
    buffer_store_dwordx4 v[84:87], v19, s[16:19], s3 offen sc1
    v_bfi_b32 v88, s5, v6, v88
    v_bfi_b32 v89, s5, v7, v89
    v_bfi_b32 v90, s5, v8, v90
    v_bfi_b32 v91, s5, v9, v91
    s_mov_b32 s3, 90112
    buffer_store_dwordx4 v[88:91], v19, s[16:19], s3 offen sc1
L_op_retry1:
    s_mov_b32 s3, 148480
    buffer_load_dwordx4 v[96:99], v19, s[16:19], s3 offen sc1
    s_mov_b32 s3, 152576
    buffer_load_dwordx4 v[100:103], v19, s[16:19], s3 offen sc1
    s_mov_b32 s3, 156672
    buffer_load_dwordx4 v[104:107], v19, s[16:19], s3 offen sc1
    s_mov_b32 s3, 160768
    buffer_load_dwordx4 v[108:111], v19, s[16:19], s3 offen sc1
    s_mov_b32 s3, 164864
    buffer_load_dwordx4 v[112:115], v19, s[16:19], s3 offen sc1
    s_mov_b32 s3, 222208
    buffer_load_dwordx4 v[116:119], v19, s[16:19], s3 offen sc1
    s_mov_b32 s3, 226304
    buffer_load_dwordx4 v[120:123], v19, s[16:19], s3 offen sc1
    s_mov_b32 s3, 230400
    buffer_load_dwordx4 v[124:127], v19, s[16:19], s3 offen sc1
    s_mov_b32 s3, 234496
    buffer_load_dwordx4 v[128:131], v19, s[16:19], s3 offen sc1
    s_mov_b32 s3, 238592
    buffer_load_dwordx4 v[132:135], v19, s[16:19], s3 offen sc1
    s_mov_b32 s3, 1024
    buffer_load_dwordx4 v[136:139], v19, s[16:19], s3 offen sc1
    s_mov_b32 s3, 5120
    buffer_load_dwordx4 v[140:143], v19, s[16:19], s3 offen sc1
    s_mov_b32 s3, 9216
    buffer_load_dwordx4 v[144:147], v19, s[16:19], s3 offen sc1
    s_mov_b32 s3, 13312
    buffer_load_dwordx4 v[148:151], v19, s[16:19], s3 offen sc1
    s_mov_b32 s3, 17408
    buffer_load_dwordx4 v[152:155], v19, s[16:19], s3 offen sc1
    v_mov_b32 v10, 0
    s_add_u32 s45, s45, 1
    s_waitcnt vmcnt(0)
    v_xor_b32 v5, v96, v6
    v_and_or_b32 v10, v5, s5, v10
    v_xor_b32 v5, v97, v7
    v_and_or_b32 v10, v5, s5, v10
    v_xor_b32 v5, v98, v8
    v_and_or_b32 v10, v5, s5, v10
    v_xor_b32 v5, v99, v9
    v_and_or_b32 v10, v5, s5, v10
    v_xor_b32 v5, v100, v6
    v_and_or_b32 v10, v5, s5, v10
    v_xor_b32 v5, v101, v7
    v_and_or_b32 v10, v5, s5, v10
    v_xor_b32 v5, v102, v8
    v_and_or_b32 v10, v5, s5, v10
    v_xor_b32 v5, v103, v9
    v_and_or_b32 v10, v5, s5, v10
    v_xor_b32 v5, v104, v6
    v_and_or_b32 v10, v5, s5, v10
    v_xor_b32 v5, v105, v7
    v_and_or_b32 v10, v5, s5, v10
    v_xor_b32 v5, v106, v8
    v_and_or_b32 v10, v5, s5, v10
    v_xor_b32 v5, v107, v9
    v_and_or_b32 v10, v5, s5, v10
    v_xor_b32 v5, v108, v6
    v_and_or_b32 v10, v5, s5, v10
    v_xor_b32 v5, v109, v7
    v_and_or_b32 v10, v5, s5, v10
    v_xor_b32 v5, v110, v8
    v_and_or_b32 v10, v5, s5, v10
    v_xor_b32 v5, v111, v9
    v_and_or_b32 v10, v5, s5, v10
    v_xor_b32 v5, v112, v6
    v_and_or_b32 v10, v5, s5, v10
    v_xor_b32 v5, v113, v7
    v_and_or_b32 v10, v5, s5, v10
    v_xor_b32 v5, v114, v8
    v_and_or_b32 v10, v5, s5, v10
    v_xor_b32 v5, v115, v9
    v_and_or_b32 v10, v5, s5, v10
    v_xor_b32 v5, v116, v6
    v_and_or_b32 v10, v5, s5, v10
    v_xor_b32 v5, v117, v7
    v_and_or_b32 v10, v5, s5, v10
    v_xor_b32 v5, v118, v8
    v_and_or_b32 v10, v5, s5, v10
    v_xor_b32 v5, v119, v9
    v_and_or_b32 v10, v5, s5, v10
    v_xor_b32 v5, v120, v6
    v_and_or_b32 v10, v5, s5, v10
    v_xor_b32 v5, v121, v7
    v_and_or_b32 v10, v5, s5, v10
    v_xor_b32 v5, v122, v8
    v_and_or_b32 v10, v5, s5, v10
    v_xor_b32 v5, v123, v9
    v_and_or_b32 v10, v5, s5, v10
    v_xor_b32 v5, v124, v6
    v_and_or_b32 v10, v5, s5, v10
    v_xor_b32 v5, v125, v7
    v_and_or_b32 v10, v5, s5, v10
    v_xor_b32 v5, v126, v8
    v_and_or_b32 v10, v5, s5, v10
    v_xor_b32 v5, v127, v9
    v_and_or_b32 v10, v5, s5, v10
    v_xor_b32 v5, v128, v6
    v_and_or_b32 v10, v5, s5, v10
    v_xor_b32 v5, v129, v7
    v_and_or_b32 v10, v5, s5, v10
    v_xor_b32 v5, v130, v8
    v_and_or_b32 v10, v5, s5, v10
    v_xor_b32 v5, v131, v9
    v_and_or_b32 v10, v5, s5, v10
    v_xor_b32 v5, v132, v6
    v_and_or_b32 v10, v5, s5, v10
    v_xor_b32 v5, v133, v7
    v_and_or_b32 v10, v5, s5, v10
    v_xor_b32 v5, v134, v8
    v_and_or_b32 v10, v5, s5, v10
    v_xor_b32 v5, v135, v9
    v_and_or_b32 v10, v5, s5, v10
    v_xor_b32 v5, v136, v6
    v_and_or_b32 v10, v5, s5, v10
    v_xor_b32 v5, v137, v7
    v_and_or_b32 v10, v5, s5, v10
    v_xor_b32 v5, v138, v8
    v_and_or_b32 v10, v5, s5, v10
    v_xor_b32 v5, v139, v9
    v_and_or_b32 v10, v5, s5, v10
    v_xor_b32 v5, v140, v6
    v_and_or_b32 v10, v5, s5, v10
    v_xor_b32 v5, v141, v7
    v_and_or_b32 v10, v5, s5, v10
    v_xor_b32 v5, v142, v8
    v_and_or_b32 v10, v5, s5, v10
    v_xor_b32 v5, v143, v9
    v_and_or_b32 v10, v5, s5, v10
    v_xor_b32 v5, v144, v6
    v_and_or_b32 v10, v5, s5, v10
    v_xor_b32 v5, v145, v7
    v_and_or_b32 v10, v5, s5, v10
    v_xor_b32 v5, v146, v8
    v_and_or_b32 v10, v5, s5, v10
    v_xor_b32 v5, v147, v9
    v_and_or_b32 v10, v5, s5, v10
    v_xor_b32 v5, v148, v6
    v_and_or_b32 v10, v5, s5, v10
    v_xor_b32 v5, v149, v7
    v_and_or_b32 v10, v5, s5, v10
    v_xor_b32 v5, v150, v8
    v_and_or_b32 v10, v5, s5, v10
    v_xor_b32 v5, v151, v9
    v_and_or_b32 v10, v5, s5, v10
    v_xor_b32 v5, v152, v6
    v_and_or_b32 v10, v5, s5, v10
    v_xor_b32 v5, v153, v7
    v_and_or_b32 v10, v5, s5, v10
    v_xor_b32 v5, v154, v8
    v_and_or_b32 v10, v5, s5, v10
    v_xor_b32 v5, v155, v9
    v_and_or_b32 v10, v5, s5, v10
    v_cmp_ne_u32 vcc, 0, v10
    s_cbranch_vccz L_op_ok1
    s_cmp_lt_u32 s45, 0x20000
    s_cbranch_scc1 L_op_retry1
L_op_ok1:
    v_add_f32 v28, v28, v96
    v_add_f32 v29, v29, v97
    v_add_f32 v30, v30, v98
    v_add_f32 v31, v31, v99
    v_add_f32 v44, v44, v100
    v_add_f32 v45, v45, v101
    v_add_f32 v46, v46, v102
    v_add_f32 v47, v47, v103
    v_add_f32 v60, v60, v104
    v_add_f32 v61, v61, v105
    v_add_f32 v62, v62, v106
    v_add_f32 v63, v63, v107
    v_add_f32 v76, v76, v108
    v_add_f32 v77, v77, v109
    v_add_f32 v78, v78, v110
    v_add_f32 v79, v79, v111
    v_add_f32 v92, v92, v112
    v_add_f32 v93, v93, v113
    v_add_f32 v94, v94, v114
    v_add_f32 v95, v95, v115
    v_add_f32 v28, v28, v116
    v_add_f32 v29, v29, v117
    v_add_f32 v30, v30, v118
    v_add_f32 v31, v31, v119
    v_add_f32 v44, v44, v120
    v_add_f32 v45, v45, v121
    v_add_f32 v46, v46, v122
    v_add_f32 v47, v47, v123
    v_add_f32 v60, v60, v124
    v_add_f32 v61, v61, v125
    v_add_f32 v62, v62, v126
    v_add_f32 v63, v63, v127
    v_add_f32 v76, v76, v128
    v_add_f32 v77, v77, v129
    v_add_f32 v78, v78, v130
    v_add_f32 v79, v79, v131
    v_add_f32 v92, v92, v132
    v_add_f32 v93, v93, v133
    v_add_f32 v94, v94, v134
    v_add_f32 v95, v95, v135
    v_add_f32 v28, v28, v136
    v_add_f32 v29, v29, v137
    v_add_f32 v30, v30, v138
    v_add_f32 v31, v31, v139
    v_add_f32 v44, v44, v140
    v_add_f32 v45, v45, v141
    v_add_f32 v46, v46, v142
    v_add_f32 v47, v47, v143
    v_add_f32 v60, v60, v144
    v_add_f32 v61, v61, v145
    v_add_f32 v62, v62, v146
    v_add_f32 v63, v63, v147
    v_add_f32 v76, v76, v148
    v_add_f32 v77, v77, v149
    v_add_f32 v78, v78, v150
    v_add_f32 v79, v79, v151
    v_add_f32 v92, v92, v152
    v_add_f32 v93, v93, v153
    v_add_f32 v94, v94, v154
    v_add_f32 v95, v95, v155
    v_cvt_pk_bf16_f32 v28, v28, v29
    v_cvt_pk_bf16_f32 v29, v30, v31
    buffer_store_dwordx2 v[28:29], v4, s[24:27], 0 offen offset:0
    v_cvt_pk_bf16_f32 v44, v44, v45
    v_cvt_pk_bf16_f32 v45, v46, v47
    buffer_store_dwordx2 v[44:45], v4, s[24:27], 0 offen offset:64
    v_cvt_pk_bf16_f32 v60, v60, v61
    v_cvt_pk_bf16_f32 v61, v62, v63
    buffer_store_dwordx2 v[60:61], v4, s[24:27], 0 offen offset:128
    v_cvt_pk_bf16_f32 v76, v76, v77
    v_cvt_pk_bf16_f32 v77, v78, v79
    buffer_store_dwordx2 v[76:77], v4, s[24:27], 0 offen offset:192
    v_cvt_pk_bf16_f32 v92, v92, v93
    v_cvt_pk_bf16_f32 v93, v94, v95
    buffer_store_dwordx2 v[92:93], v4, s[24:27], 0 offen offset:256
    s_branch L_op_fin
L_op_red2:
    v_bfi_b32 v24, s5, v6, v24
    v_bfi_b32 v25, s5, v7, v25
    v_bfi_b32 v26, s5, v8, v26
    v_bfi_b32 v27, s5, v9, v27
    s_mov_b32 s3, 147456
    buffer_store_dwordx4 v[24:27], v19, s[16:19], s3 offen sc1
    v_bfi_b32 v28, s5, v6, v28
    v_bfi_b32 v29, s5, v7, v29
    v_bfi_b32 v30, s5, v8, v30
    v_bfi_b32 v31, s5, v9, v31
    s_mov_b32 s3, 148480
    buffer_store_dwordx4 v[28:31], v19, s[16:19], s3 offen sc1
    v_bfi_b32 v36, s5, v6, v36
    v_bfi_b32 v37, s5, v7, v37
    v_bfi_b32 v38, s5, v8, v38
    v_bfi_b32 v39, s5, v9, v39
    s_mov_b32 s3, 150528
    buffer_store_dwordx4 v[36:39], v19, s[16:19], s3 offen sc1
    v_bfi_b32 v40, s5, v6, v40
    v_bfi_b32 v41, s5, v7, v41
    v_bfi_b32 v42, s5, v8, v42
    v_bfi_b32 v43, s5, v9, v43
    s_mov_b32 s3, 151552
    buffer_store_dwordx4 v[40:43], v19, s[16:19], s3 offen sc1
    v_bfi_b32 v44, s5, v6, v44
    v_bfi_b32 v45, s5, v7, v45
    v_bfi_b32 v46, s5, v8, v46
    v_bfi_b32 v47, s5, v9, v47
    s_mov_b32 s3, 152576
    buffer_store_dwordx4 v[44:47], v19, s[16:19], s3 offen sc1
    v_bfi_b32 v52, s5, v6, v52
    v_bfi_b32 v53, s5, v7, v53
    v_bfi_b32 v54, s5, v8, v54
    v_bfi_b32 v55, s5, v9, v55
    s_mov_b32 s3, 154624
    buffer_store_dwordx4 v[52:55], v19, s[16:19], s3 offen sc1
    v_bfi_b32 v56, s5, v6, v56
    v_bfi_b32 v57, s5, v7, v57
    v_bfi_b32 v58, s5, v8, v58
    v_bfi_b32 v59, s5, v9, v59
    s_mov_b32 s3, 155648
    buffer_store_dwordx4 v[56:59], v19, s[16:19], s3 offen sc1
    v_bfi_b32 v60, s5, v6, v60
    v_bfi_b32 v61, s5, v7, v61
    v_bfi_b32 v62, s5, v8, v62
    v_bfi_b32 v63, s5, v9, v63
    s_mov_b32 s3, 156672
    buffer_store_dwordx4 v[60:63], v19, s[16:19], s3 offen sc1
    v_bfi_b32 v68, s5, v6, v68
    v_bfi_b32 v69, s5, v7, v69
    v_bfi_b32 v70, s5, v8, v70
    v_bfi_b32 v71, s5, v9, v71
    s_mov_b32 s3, 158720
    buffer_store_dwordx4 v[68:71], v19, s[16:19], s3 offen sc1
    v_bfi_b32 v72, s5, v6, v72
    v_bfi_b32 v73, s5, v7, v73
    v_bfi_b32 v74, s5, v8, v74
    v_bfi_b32 v75, s5, v9, v75
    s_mov_b32 s3, 159744
    buffer_store_dwordx4 v[72:75], v19, s[16:19], s3 offen sc1
    v_bfi_b32 v76, s5, v6, v76
    v_bfi_b32 v77, s5, v7, v77
    v_bfi_b32 v78, s5, v8, v78
    v_bfi_b32 v79, s5, v9, v79
    s_mov_b32 s3, 160768
    buffer_store_dwordx4 v[76:79], v19, s[16:19], s3 offen sc1
    v_bfi_b32 v84, s5, v6, v84
    v_bfi_b32 v85, s5, v7, v85
    v_bfi_b32 v86, s5, v8, v86
    v_bfi_b32 v87, s5, v9, v87
    s_mov_b32 s3, 162816
    buffer_store_dwordx4 v[84:87], v19, s[16:19], s3 offen sc1
    v_bfi_b32 v88, s5, v6, v88
    v_bfi_b32 v89, s5, v7, v89
    v_bfi_b32 v90, s5, v8, v90
    v_bfi_b32 v91, s5, v9, v91
    s_mov_b32 s3, 163840
    buffer_store_dwordx4 v[88:91], v19, s[16:19], s3 offen sc1
    v_bfi_b32 v92, s5, v6, v92
    v_bfi_b32 v93, s5, v7, v93
    v_bfi_b32 v94, s5, v8, v94
    v_bfi_b32 v95, s5, v9, v95
    s_mov_b32 s3, 164864
    buffer_store_dwordx4 v[92:95], v19, s[16:19], s3 offen sc1
L_op_retry2:
    s_mov_b32 s3, 223232
    buffer_load_dwordx4 v[96:99], v19, s[16:19], s3 offen sc1
    s_mov_b32 s3, 227328
    buffer_load_dwordx4 v[100:103], v19, s[16:19], s3 offen sc1
    s_mov_b32 s3, 231424
    buffer_load_dwordx4 v[104:107], v19, s[16:19], s3 offen sc1
    s_mov_b32 s3, 235520
    buffer_load_dwordx4 v[108:111], v19, s[16:19], s3 offen sc1
    s_mov_b32 s3, 2048
    buffer_load_dwordx4 v[112:115], v19, s[16:19], s3 offen sc1
    s_mov_b32 s3, 6144
    buffer_load_dwordx4 v[116:119], v19, s[16:19], s3 offen sc1
    s_mov_b32 s3, 10240
    buffer_load_dwordx4 v[120:123], v19, s[16:19], s3 offen sc1
    s_mov_b32 s3, 14336
    buffer_load_dwordx4 v[124:127], v19, s[16:19], s3 offen sc1
    s_mov_b32 s3, 75776
    buffer_load_dwordx4 v[128:131], v19, s[16:19], s3 offen sc1
    s_mov_b32 s3, 79872
    buffer_load_dwordx4 v[132:135], v19, s[16:19], s3 offen sc1
    s_mov_b32 s3, 83968
    buffer_load_dwordx4 v[136:139], v19, s[16:19], s3 offen sc1
    s_mov_b32 s3, 88064
    buffer_load_dwordx4 v[140:143], v19, s[16:19], s3 offen sc1
    v_mov_b32 v10, 0
    s_add_u32 s45, s45, 1
    s_waitcnt vmcnt(0)
    v_xor_b32 v5, v96, v6
    v_and_or_b32 v10, v5, s5, v10
    v_xor_b32 v5, v97, v7
    v_and_or_b32 v10, v5, s5, v10
    v_xor_b32 v5, v98, v8
    v_and_or_b32 v10, v5, s5, v10
    v_xor_b32 v5, v99, v9
    v_and_or_b32 v10, v5, s5, v10
    v_xor_b32 v5, v100, v6
    v_and_or_b32 v10, v5, s5, v10
    v_xor_b32 v5, v101, v7
    v_and_or_b32 v10, v5, s5, v10
    v_xor_b32 v5, v102, v8
    v_and_or_b32 v10, v5, s5, v10
    v_xor_b32 v5, v103, v9
    v_and_or_b32 v10, v5, s5, v10
    v_xor_b32 v5, v104, v6
    v_and_or_b32 v10, v5, s5, v10
    v_xor_b32 v5, v105, v7
    v_and_or_b32 v10, v5, s5, v10
    v_xor_b32 v5, v106, v8
    v_and_or_b32 v10, v5, s5, v10
    v_xor_b32 v5, v107, v9
    v_and_or_b32 v10, v5, s5, v10
    v_xor_b32 v5, v108, v6
    v_and_or_b32 v10, v5, s5, v10
    v_xor_b32 v5, v109, v7
    v_and_or_b32 v10, v5, s5, v10
    v_xor_b32 v5, v110, v8
    v_and_or_b32 v10, v5, s5, v10
    v_xor_b32 v5, v111, v9
    v_and_or_b32 v10, v5, s5, v10
    v_xor_b32 v5, v112, v6
    v_and_or_b32 v10, v5, s5, v10
    v_xor_b32 v5, v113, v7
    v_and_or_b32 v10, v5, s5, v10
    v_xor_b32 v5, v114, v8
    v_and_or_b32 v10, v5, s5, v10
    v_xor_b32 v5, v115, v9
    v_and_or_b32 v10, v5, s5, v10
    v_xor_b32 v5, v116, v6
    v_and_or_b32 v10, v5, s5, v10
    v_xor_b32 v5, v117, v7
    v_and_or_b32 v10, v5, s5, v10
    v_xor_b32 v5, v118, v8
    v_and_or_b32 v10, v5, s5, v10
    v_xor_b32 v5, v119, v9
    v_and_or_b32 v10, v5, s5, v10
    v_xor_b32 v5, v120, v6
    v_and_or_b32 v10, v5, s5, v10
    v_xor_b32 v5, v121, v7
    v_and_or_b32 v10, v5, s5, v10
    v_xor_b32 v5, v122, v8
    v_and_or_b32 v10, v5, s5, v10
    v_xor_b32 v5, v123, v9
    v_and_or_b32 v10, v5, s5, v10
    v_xor_b32 v5, v124, v6
    v_and_or_b32 v10, v5, s5, v10
    v_xor_b32 v5, v125, v7
    v_and_or_b32 v10, v5, s5, v10
    v_xor_b32 v5, v126, v8
    v_and_or_b32 v10, v5, s5, v10
    v_xor_b32 v5, v127, v9
    v_and_or_b32 v10, v5, s5, v10
    v_xor_b32 v5, v128, v6
    v_and_or_b32 v10, v5, s5, v10
    v_xor_b32 v5, v129, v7
    v_and_or_b32 v10, v5, s5, v10
    v_xor_b32 v5, v130, v8
    v_and_or_b32 v10, v5, s5, v10
    v_xor_b32 v5, v131, v9
    v_and_or_b32 v10, v5, s5, v10
    v_xor_b32 v5, v132, v6
    v_and_or_b32 v10, v5, s5, v10
    v_xor_b32 v5, v133, v7
    v_and_or_b32 v10, v5, s5, v10
    v_xor_b32 v5, v134, v8
    v_and_or_b32 v10, v5, s5, v10
    v_xor_b32 v5, v135, v9
    v_and_or_b32 v10, v5, s5, v10
    v_xor_b32 v5, v136, v6
    v_and_or_b32 v10, v5, s5, v10
    v_xor_b32 v5, v137, v7
    v_and_or_b32 v10, v5, s5, v10
    v_xor_b32 v5, v138, v8
    v_and_or_b32 v10, v5, s5, v10
    v_xor_b32 v5, v139, v9
    v_and_or_b32 v10, v5, s5, v10
    v_xor_b32 v5, v140, v6
    v_and_or_b32 v10, v5, s5, v10
    v_xor_b32 v5, v141, v7
    v_and_or_b32 v10, v5, s5, v10
    v_xor_b32 v5, v142, v8
    v_and_or_b32 v10, v5, s5, v10
    v_xor_b32 v5, v143, v9
    v_and_or_b32 v10, v5, s5, v10
    v_cmp_ne_u32 vcc, 0, v10
    s_cbranch_vccz L_op_ok2
    s_cmp_lt_u32 s45, 0x20000
    s_cbranch_scc1 L_op_retry2
L_op_ok2:
    v_add_f32 v32, v32, v96
    v_add_f32 v33, v33, v97
    v_add_f32 v34, v34, v98
    v_add_f32 v35, v35, v99
    v_add_f32 v48, v48, v100
    v_add_f32 v49, v49, v101
    v_add_f32 v50, v50, v102
    v_add_f32 v51, v51, v103
    v_add_f32 v64, v64, v104
    v_add_f32 v65, v65, v105
    v_add_f32 v66, v66, v106
    v_add_f32 v67, v67, v107
    v_add_f32 v80, v80, v108
    v_add_f32 v81, v81, v109
    v_add_f32 v82, v82, v110
    v_add_f32 v83, v83, v111
    v_add_f32 v32, v32, v112
    v_add_f32 v33, v33, v113
    v_add_f32 v34, v34, v114
    v_add_f32 v35, v35, v115
    v_add_f32 v48, v48, v116
    v_add_f32 v49, v49, v117
    v_add_f32 v50, v50, v118
    v_add_f32 v51, v51, v119
    v_add_f32 v64, v64, v120
    v_add_f32 v65, v65, v121
    v_add_f32 v66, v66, v122
    v_add_f32 v67, v67, v123
    v_add_f32 v80, v80, v124
    v_add_f32 v81, v81, v125
    v_add_f32 v82, v82, v126
    v_add_f32 v83, v83, v127
    v_add_f32 v32, v32, v128
    v_add_f32 v33, v33, v129
    v_add_f32 v34, v34, v130
    v_add_f32 v35, v35, v131
    v_add_f32 v48, v48, v132
    v_add_f32 v49, v49, v133
    v_add_f32 v50, v50, v134
    v_add_f32 v51, v51, v135
    v_add_f32 v64, v64, v136
    v_add_f32 v65, v65, v137
    v_add_f32 v66, v66, v138
    v_add_f32 v67, v67, v139
    v_add_f32 v80, v80, v140
    v_add_f32 v81, v81, v141
    v_add_f32 v82, v82, v142
    v_add_f32 v83, v83, v143
    v_cvt_pk_bf16_f32 v32, v32, v33
    v_cvt_pk_bf16_f32 v33, v34, v35
    buffer_store_dwordx2 v[32:33], v3, s[24:27], 0 offen offset:32
    v_cvt_pk_bf16_f32 v48, v48, v49
    v_cvt_pk_bf16_f32 v49, v50, v51
    buffer_store_dwordx2 v[48:49], v3, s[24:27], 0 offen offset:96
    v_cvt_pk_bf16_f32 v64, v64, v65
    v_cvt_pk_bf16_f32 v65, v66, v67
    buffer_store_dwordx2 v[64:65], v3, s[24:27], 0 offen offset:160
    v_cvt_pk_bf16_f32 v80, v80, v81
    v_cvt_pk_bf16_f32 v81, v82, v83
    buffer_store_dwordx2 v[80:81], v3, s[24:27], 0 offen offset:224
    s_branch L_op_fin
L_op_red3:
    v_bfi_b32 v24, s5, v6, v24
    v_bfi_b32 v25, s5, v7, v25
    v_bfi_b32 v26, s5, v8, v26
    v_bfi_b32 v27, s5, v9, v27
    s_mov_b32 s3, 221184
    buffer_store_dwordx4 v[24:27], v19, s[16:19], s3 offen sc1
    v_bfi_b32 v28, s5, v6, v28
    v_bfi_b32 v29, s5, v7, v29
    v_bfi_b32 v30, s5, v8, v30
    v_bfi_b32 v31, s5, v9, v31
    s_mov_b32 s3, 222208
    buffer_store_dwordx4 v[28:31], v19, s[16:19], s3 offen sc1
    v_bfi_b32 v32, s5, v6, v32
    v_bfi_b32 v33, s5, v7, v33
    v_bfi_b32 v34, s5, v8, v34
    v_bfi_b32 v35, s5, v9, v35
    s_mov_b32 s3, 223232
    buffer_store_dwordx4 v[32:35], v19, s[16:19], s3 offen sc1
    v_bfi_b32 v40, s5, v6, v40
    v_bfi_b32 v41, s5, v7, v41
    v_bfi_b32 v42, s5, v8, v42
    v_bfi_b32 v43, s5, v9, v43
    s_mov_b32 s3, 225280
    buffer_store_dwordx4 v[40:43], v19, s[16:19], s3 offen sc1
    v_bfi_b32 v44, s5, v6, v44
    v_bfi_b32 v45, s5, v7, v45
    v_bfi_b32 v46, s5, v8, v46
    v_bfi_b32 v47, s5, v9, v47
    s_mov_b32 s3, 226304
    buffer_store_dwordx4 v[44:47], v19, s[16:19], s3 offen sc1
    v_bfi_b32 v48, s5, v6, v48
    v_bfi_b32 v49, s5, v7, v49
    v_bfi_b32 v50, s5, v8, v50
    v_bfi_b32 v51, s5, v9, v51
    s_mov_b32 s3, 227328
    buffer_store_dwordx4 v[48:51], v19, s[16:19], s3 offen sc1
    v_bfi_b32 v56, s5, v6, v56
    v_bfi_b32 v57, s5, v7, v57
    v_bfi_b32 v58, s5, v8, v58
    v_bfi_b32 v59, s5, v9, v59
    s_mov_b32 s3, 229376
    buffer_store_dwordx4 v[56:59], v19, s[16:19], s3 offen sc1
    v_bfi_b32 v60, s5, v6, v60
    v_bfi_b32 v61, s5, v7, v61
    v_bfi_b32 v62, s5, v8, v62
    v_bfi_b32 v63, s5, v9, v63
    s_mov_b32 s3, 230400
    buffer_store_dwordx4 v[60:63], v19, s[16:19], s3 offen sc1
    v_bfi_b32 v64, s5, v6, v64
    v_bfi_b32 v65, s5, v7, v65
    v_bfi_b32 v66, s5, v8, v66
    v_bfi_b32 v67, s5, v9, v67
    s_mov_b32 s3, 231424
    buffer_store_dwordx4 v[64:67], v19, s[16:19], s3 offen sc1
    v_bfi_b32 v72, s5, v6, v72
    v_bfi_b32 v73, s5, v7, v73
    v_bfi_b32 v74, s5, v8, v74
    v_bfi_b32 v75, s5, v9, v75
    s_mov_b32 s3, 233472
    buffer_store_dwordx4 v[72:75], v19, s[16:19], s3 offen sc1
    v_bfi_b32 v76, s5, v6, v76
    v_bfi_b32 v77, s5, v7, v77
    v_bfi_b32 v78, s5, v8, v78
    v_bfi_b32 v79, s5, v9, v79
    s_mov_b32 s3, 234496
    buffer_store_dwordx4 v[76:79], v19, s[16:19], s3 offen sc1
    v_bfi_b32 v80, s5, v6, v80
    v_bfi_b32 v81, s5, v7, v81
    v_bfi_b32 v82, s5, v8, v82
    v_bfi_b32 v83, s5, v9, v83
    s_mov_b32 s3, 235520
    buffer_store_dwordx4 v[80:83], v19, s[16:19], s3 offen sc1
    v_bfi_b32 v88, s5, v6, v88
    v_bfi_b32 v89, s5, v7, v89
    v_bfi_b32 v90, s5, v8, v90
    v_bfi_b32 v91, s5, v9, v91
    s_mov_b32 s3, 237568
    buffer_store_dwordx4 v[88:91], v19, s[16:19], s3 offen sc1
    v_bfi_b32 v92, s5, v6, v92
    v_bfi_b32 v93, s5, v7, v93
    v_bfi_b32 v94, s5, v8, v94
    v_bfi_b32 v95, s5, v9, v95
    s_mov_b32 s3, 238592
    buffer_store_dwordx4 v[92:95], v19, s[16:19], s3 offen sc1
L_op_retry3:
    s_mov_b32 s3, 3072
    buffer_load_dwordx4 v[96:99], v19, s[16:19], s3 offen sc1
    s_mov_b32 s3, 7168
    buffer_load_dwordx4 v[100:103], v19, s[16:19], s3 offen sc1
    s_mov_b32 s3, 11264
    buffer_load_dwordx4 v[104:107], v19, s[16:19], s3 offen sc1
    s_mov_b32 s3, 15360
    buffer_load_dwordx4 v[108:111], v19, s[16:19], s3 offen sc1
    s_mov_b32 s3, 76800
    buffer_load_dwordx4 v[112:115], v19, s[16:19], s3 offen sc1
    s_mov_b32 s3, 80896
    buffer_load_dwordx4 v[116:119], v19, s[16:19], s3 offen sc1
    s_mov_b32 s3, 84992
    buffer_load_dwordx4 v[120:123], v19, s[16:19], s3 offen sc1
    s_mov_b32 s3, 89088
    buffer_load_dwordx4 v[124:127], v19, s[16:19], s3 offen sc1
    s_mov_b32 s3, 150528
    buffer_load_dwordx4 v[128:131], v19, s[16:19], s3 offen sc1
    s_mov_b32 s3, 154624
    buffer_load_dwordx4 v[132:135], v19, s[16:19], s3 offen sc1
    s_mov_b32 s3, 158720
    buffer_load_dwordx4 v[136:139], v19, s[16:19], s3 offen sc1
    s_mov_b32 s3, 162816
    buffer_load_dwordx4 v[140:143], v19, s[16:19], s3 offen sc1
    v_mov_b32 v10, 0
    s_add_u32 s45, s45, 1
    s_waitcnt vmcnt(0)
    v_xor_b32 v5, v96, v6
    v_and_or_b32 v10, v5, s5, v10
    v_xor_b32 v5, v97, v7
    v_and_or_b32 v10, v5, s5, v10
    v_xor_b32 v5, v98, v8
    v_and_or_b32 v10, v5, s5, v10
    v_xor_b32 v5, v99, v9
    v_and_or_b32 v10, v5, s5, v10
    v_xor_b32 v5, v100, v6
    v_and_or_b32 v10, v5, s5, v10
    v_xor_b32 v5, v101, v7
    v_and_or_b32 v10, v5, s5, v10
    v_xor_b32 v5, v102, v8
    v_and_or_b32 v10, v5, s5, v10
    v_xor_b32 v5, v103, v9
    v_and_or_b32 v10, v5, s5, v10
    v_xor_b32 v5, v104, v6
    v_and_or_b32 v10, v5, s5, v10
    v_xor_b32 v5, v105, v7
    v_and_or_b32 v10, v5, s5, v10
    v_xor_b32 v5, v106, v8
    v_and_or_b32 v10, v5, s5, v10
    v_xor_b32 v5, v107, v9
    v_and_or_b32 v10, v5, s5, v10
    v_xor_b32 v5, v108, v6
    v_and_or_b32 v10, v5, s5, v10
    v_xor_b32 v5, v109, v7
    v_and_or_b32 v10, v5, s5, v10
    v_xor_b32 v5, v110, v8
    v_and_or_b32 v10, v5, s5, v10
    v_xor_b32 v5, v111, v9
    v_and_or_b32 v10, v5, s5, v10
    v_xor_b32 v5, v112, v6
    v_and_or_b32 v10, v5, s5, v10
    v_xor_b32 v5, v113, v7
    v_and_or_b32 v10, v5, s5, v10
    v_xor_b32 v5, v114, v8
    v_and_or_b32 v10, v5, s5, v10
    v_xor_b32 v5, v115, v9
    v_and_or_b32 v10, v5, s5, v10
    v_xor_b32 v5, v116, v6
    v_and_or_b32 v10, v5, s5, v10
    v_xor_b32 v5, v117, v7
    v_and_or_b32 v10, v5, s5, v10
    v_xor_b32 v5, v118, v8
    v_and_or_b32 v10, v5, s5, v10
    v_xor_b32 v5, v119, v9
    v_and_or_b32 v10, v5, s5, v10
    v_xor_b32 v5, v120, v6
    v_and_or_b32 v10, v5, s5, v10
    v_xor_b32 v5, v121, v7
    v_and_or_b32 v10, v5, s5, v10
    v_xor_b32 v5, v122, v8
    v_and_or_b32 v10, v5, s5, v10
    v_xor_b32 v5, v123, v9
    v_and_or_b32 v10, v5, s5, v10
    v_xor_b32 v5, v124, v6
    v_and_or_b32 v10, v5, s5, v10
    v_xor_b32 v5, v125, v7
    v_and_or_b32 v10, v5, s5, v10
    v_xor_b32 v5, v126, v8
    v_and_or_b32 v10, v5, s5, v10
    v_xor_b32 v5, v127, v9
    v_and_or_b32 v10, v5, s5, v10
    v_xor_b32 v5, v128, v6
    v_and_or_b32 v10, v5, s5, v10
    v_xor_b32 v5, v129, v7
    v_and_or_b32 v10, v5, s5, v10
    v_xor_b32 v5, v130, v8
    v_and_or_b32 v10, v5, s5, v10
    v_xor_b32 v5, v131, v9
    v_and_or_b32 v10, v5, s5, v10
    v_xor_b32 v5, v132, v6
    v_and_or_b32 v10, v5, s5, v10
    v_xor_b32 v5, v133, v7
    v_and_or_b32 v10, v5, s5, v10
    v_xor_b32 v5, v134, v8
    v_and_or_b32 v10, v5, s5, v10
    v_xor_b32 v5, v135, v9
    v_and_or_b32 v10, v5, s5, v10
    v_xor_b32 v5, v136, v6
    v_and_or_b32 v10, v5, s5, v10
    v_xor_b32 v5, v137, v7
    v_and_or_b32 v10, v5, s5, v10
    v_xor_b32 v5, v138, v8
    v_and_or_b32 v10, v5, s5, v10
    v_xor_b32 v5, v139, v9
    v_and_or_b32 v10, v5, s5, v10
    v_xor_b32 v5, v140, v6
    v_and_or_b32 v10, v5, s5, v10
    v_xor_b32 v5, v141, v7
    v_and_or_b32 v10, v5, s5, v10
    v_xor_b32 v5, v142, v8
    v_and_or_b32 v10, v5, s5, v10
    v_xor_b32 v5, v143, v9
    v_and_or_b32 v10, v5, s5, v10
    v_cmp_ne_u32 vcc, 0, v10
    s_cbranch_vccz L_op_ok3
    s_cmp_lt_u32 s45, 0x20000
    s_cbranch_scc1 L_op_retry3
L_op_ok3:
    v_add_f32 v36, v36, v96
    v_add_f32 v37, v37, v97
    v_add_f32 v38, v38, v98
    v_add_f32 v39, v39, v99
    v_add_f32 v52, v52, v100
    v_add_f32 v53, v53, v101
    v_add_f32 v54, v54, v102
    v_add_f32 v55, v55, v103
    v_add_f32 v68, v68, v104
    v_add_f32 v69, v69, v105
    v_add_f32 v70, v70, v106
    v_add_f32 v71, v71, v107
    v_add_f32 v84, v84, v108
    v_add_f32 v85, v85, v109
    v_add_f32 v86, v86, v110
    v_add_f32 v87, v87, v111
    v_add_f32 v36, v36, v112
    v_add_f32 v37, v37, v113
    v_add_f32 v38, v38, v114
    v_add_f32 v39, v39, v115
    v_add_f32 v52, v52, v116
    v_add_f32 v53, v53, v117
    v_add_f32 v54, v54, v118
    v_add_f32 v55, v55, v119
    v_add_f32 v68, v68, v120
    v_add_f32 v69, v69, v121
    v_add_f32 v70, v70, v122
    v_add_f32 v71, v71, v123
    v_add_f32 v84, v84, v124
    v_add_f32 v85, v85, v125
    v_add_f32 v86, v86, v126
    v_add_f32 v87, v87, v127
    v_add_f32 v36, v36, v128
    v_add_f32 v37, v37, v129
    v_add_f32 v38, v38, v130
    v_add_f32 v39, v39, v131
    v_add_f32 v52, v52, v132
    v_add_f32 v53, v53, v133
    v_add_f32 v54, v54, v134
    v_add_f32 v55, v55, v135
    v_add_f32 v68, v68, v136
    v_add_f32 v69, v69, v137
    v_add_f32 v70, v70, v138
    v_add_f32 v71, v71, v139
    v_add_f32 v84, v84, v140
    v_add_f32 v85, v85, v141
    v_add_f32 v86, v86, v142
    v_add_f32 v87, v87, v143
    v_cvt_pk_bf16_f32 v36, v36, v37
    v_cvt_pk_bf16_f32 v37, v38, v39
    buffer_store_dwordx2 v[36:37], v4, s[24:27], 0 offen offset:32
    v_cvt_pk_bf16_f32 v52, v52, v53
    v_cvt_pk_bf16_f32 v53, v54, v55
    buffer_store_dwordx2 v[52:53], v4, s[24:27], 0 offen offset:96
    v_cvt_pk_bf16_f32 v68, v68, v69
    v_cvt_pk_bf16_f32 v69, v70, v71
    buffer_store_dwordx2 v[68:69], v4, s[24:27], 0 offen offset:160
    v_cvt_pk_bf16_f32 v84, v84, v85
    v_cvt_pk_bf16_f32 v85, v86, v87
    buffer_store_dwordx2 v[84:85], v4, s[24:27], 0 offen offset:224
L_op_fin:
L_op_end:
    s_endpgm
.section .rodata,"a"
.p2align 6
.amdhsa_kernel attn_kernel
  .amdhsa_next_free_vgpr 256
  .amdhsa_next_free_sgpr 102
  .amdhsa_accum_offset 256
  .amdhsa_group_segment_fixed_size 0
  .amdhsa_kernarg_size 104
  .amdhsa_user_sgpr_count 2
  .amdhsa_user_sgpr_kernarg_segment_ptr 1
  .amdhsa_system_sgpr_workgroup_id_x 1
.end_amdhsa_kernel
.p2align 6
.amdhsa_kernel oproj_kernel
  .amdhsa_next_free_vgpr 256
  .amdhsa_next_free_sgpr 102
  .amdhsa_accum_offset 256
  .amdhsa_group_segment_fixed_size 0
  .amdhsa_kernarg_size 104
  .amdhsa_user_sgpr_count 2
  .amdhsa_user_sgpr_kernarg_segment_ptr 1
  .amdhsa_system_sgpr_workgroup_id_x 1
.end_amdhsa_kernel
```
